```python
import torch

def _softmax(x, axis=-1):
    return torch.softmax(x, dim=axis)
def _gelu(x):
    return torch.nn.functional.gelu(x, approximate="tanh")
def _silu(x):
    return torch.nn.functional.silu(x)
def _sigmoid(x):
    return torch.sigmoid(x)
def _layernorm(x, axis=-1, eps=1e-5):
    m = x.mean(dim=axis, keepdim=True)
    v = x.var(dim=axis, keepdim=True, unbiased=False)
    return (x - m) / torch.sqrt(v + eps)
def _scatter_add(tgt, idx, src, axis=0):
    return tgt.clone().index_add_(axis, idx, src)
def _segment_sum(src, seg, n):
    out = torch.zeros((n,) + src.shape[1:], dtype=src.dtype)
    return out.index_add_(0, seg, src)
def _pad(x, pw):
    flat = tuple(v for pair in reversed(pw) for v in pair)
    return torch.nn.functional.pad(x, flat)

kernel_name = 'sequential_preLN__compressed_kv_cla__dense_activation_silu__decode'

def setup_inputs():

    _w = (lambda a: (lambda t: t.to(torch.bfloat16) if t.is_floating_point() else t)(torch.as_tensor(a)))
    def _A_setup():
        B, H, Sq, Sk, D, M = 2, 32, 1, 4096, 128, 640
        Dc = 4 * D
        return {
            "x": _w((lambda *s: torch.randn(*s, dtype=torch.bfloat16) * 0.05)(B, Sq, M)),
            "c_kv": _w((lambda *s: torch.randn(*s, dtype=torch.bfloat16) * 0.8)(B, Sk, Dc)),
            "w_q": _w((lambda *s: torch.randn(*s, dtype=torch.bfloat16) * 3.2)(M, H, D) * (M ** -0.5)),
            "w_uk": _w((lambda *s: torch.randn(*s, dtype=torch.bfloat16) * 3.2)(Dc, H, D) * (Dc ** -0.5)),
            "w_uv": _w((lambda *s: torch.randn(*s, dtype=torch.bfloat16) * 0.8)(Dc, H, D) * (Dc ** -0.5)),
            "w_o": _w((lambda *s: torch.randn(*s, dtype=torch.bfloat16) * 0.8)(H, D, M) * ((H * D) ** -0.5)),
        }
    _A_in = _A_setup()

    def _B_setup():
        B, S, D, F = 2, 1, 640, 1728
        return {
            "x": _w((lambda *s: torch.randn(*s, dtype=torch.bfloat16) * 0.05)(B, S, D)),
            "w1": _w((lambda *s: torch.randn(*s, dtype=torch.bfloat16) * 3.2)(D, F) * (D ** -0.5)),
            "w2": _w((lambda *s: torch.randn(*s, dtype=torch.bfloat16) * 0.4)(F, D) * (F ** -0.5)),
        }
    _B_in = _B_setup()

    return {
        "A_x": _A_in["x"],
        "A_c_kv": _A_in["c_kv"],
        "A_w_q": _A_in["w_q"],
        "A_w_uk": _A_in["w_uk"],
        "A_w_uv": _A_in["w_uv"],
        "A_w_o": _A_in["w_o"],
        "B_x": _B_in["x"],
        "B_w1": _B_in["w1"],
        "B_w2": _B_in["w2"],
    }

def reference(A_x, A_c_kv, A_w_q, A_w_uk, A_w_uv, A_w_o, B_x, B_w1, B_w2):
    def _A_ref(x, c_kv, w_q, w_uk, w_uv, w_o):
        B, Sq, M = x.shape[0], x.shape[1], x.shape[2]
        Sk = c_kv.shape[1]
        H, D = w_q.shape[1], w_q.shape[2]
        q = torch.einsum("bqm,mhd->bhqd", x, w_q)
        k = torch.einsum("bkc,chd->bhkd", c_kv, w_uk)
        v = torch.einsum("bkc,chd->bhkd", c_kv, w_uv)
        scores = torch.einsum("bhqd,bhkd->bhqk", q, k) * (D ** -0.5)
        off = Sk - Sq
        qi = torch.arange(Sq)[:, None]
        kj = torch.arange(Sk)[None, :]
        cmask = kj <= (qi + off)
        scores = torch.where(cmask[None, None], scores, -1e9)
        p = _softmax(scores, axis=-1)
        ctx = torch.einsum("bhqk,bhkd->bhqd", p, v)
        return torch.einsum("bhqd,hdm->bqm", ctx, w_o)

    def _B_ref(x, w1, w2):
        h = torch.einsum("bsd,df->bsf", x, w1)
        h = _silu(h)
        out = torch.einsum("bsf,fd->bsd", h, w2)
        return out

    x = A_x
    h = x + _A_ref(_layernorm(x, axis=-1), A_c_kv, A_w_q, A_w_uk, A_w_uv, A_w_o)
    h2 = h + _B_ref(_layernorm(h, axis=-1), B_w1, B_w2)
    return h2
```

```asm
; @launch grid=(256,1,1) block=(256,1,1) lds=153600
.amdgcn_target "amdgcn-amd-amdhsa--gfx950"
.text
.p2align 12
.fill 832, 4, 0xbf810000
.globl sequential_preLN__compressed_kv_cla__dense_activation_silu__decode_kernel
.p2align 8
.type sequential_preLN__compressed_kv_cla__dense_activation_silu__decode_kernel,@function
sequential_preLN__compressed_kv_cla__dense_activation_silu__decode_kernel:
  s_cmp_ge_u32 s2, 256
  s_cbranch_scc1 L_end
  s_load_dwordx16 s[4:19], s[0:1], 0
  s_load_dwordx8 s[20:27], s[0:1], 64
  v_lshrrev_b32 v1, 6, v0
  v_and_b32 v2, 63, v0
  v_and_b32 v3, 15, v0
  v_readfirstlane_b32 s54, v1
  v_bfe_u32 v4, v0, 4, 2
  s_and_b32 s52, s2, 7
  s_lshr_b32 s53, s2, 3
  s_mov_b32 s30, 5242880
  s_mov_b32 s31, 0x20000
  s_getpc_b64 s[66:67]
L_pc:
  s_lshl_b32 s60, s53, 2
  s_add_u32 s60, s60, s54
  s_mul_i32 s60, s60, 192
  s_min_u32 s60, s60, L_codeend-L_pc-132
  s_add_u32 s66, s66, s60
  s_addc_u32 s67, s67, 0
  s_cmp_lt_u32 s53, 16
  s_cbranch_scc1 L_roleW
  s_mov_b32 s34, 8388608
  s_mov_b32 s35, 0x20000
  s_mov_b32 s38, 5242880
  s_mov_b32 s39, 0x20000
  s_mov_b32 s42, 4194304
  s_mov_b32 s43, 0x20000
  s_lshl_b32 s69, s52, 4
  s_add_u32 s69, s69, s53
  s_sub_u32 s69, s69, 16
  s_and_b32 s70, s53, 1
  v_lshrrev_b32 v10, 3, v2
  v_and_b32 v11, 7, v2
  v_lshlrev_b32 v11, 7, v11
  v_lshl_or_b32 v14, v10, 13, v11
  v_lshlrev_b32 v10, 1, v4
  v_xor_b32 v10, v10, v3
  v_lshlrev_b32 v10, 4, v10
  v_lshl_or_b32 v6, v4, 10, v10
  v_xor_b32 v7, 4224, v6
  v_xor_b32 v8, 8208, v6
  v_xor_b32 v9, 12432, v6
  s_and_b32 s60, s53, 3
  s_mul_i32 s60, s60, 160
  s_bfe_u32 s61, s53, 0x20002
  s_lshl_b32 s61, s61, 3
  s_add_u32 s60, s60, s61
  s_lshl_b32 s61, s54, 5
  s_add_u32 s60, s60, s61
  s_add_u32 s60, s60, 96
  s_lshl_b32 s60, s60, 13
  s_lshl_b32 s62, s52, 10
  s_add_u32 s60, s60, s62
  s_and_b32 s61, s53, 15
  s_lshl_b32 s61, s61, 2
  s_add_u32 s61, s61, s54
  s_add_u32 s61, s61, -2
  s_lshl_b32 s61, s61, 16
  s_add_u32 s61, s61, s62
  s_lshr_b32 s62, s69, 1
  s_lshl_b32 s62, s62, 17
  s_lshl_b32 s63, s54, 15
  s_add_u32 s62, s62, s63
  s_lshl_b32 s63, s70, 14
  s_lshl_b32 s71, s54, 13
  s_waitcnt lgkmcnt(0)
  s_mov_b64 s[36:37], s[8:9]
  s_mov_b64 s[40:41], s[10:11]
  s_mov_b64 s[32:33], s[6:7]
  s_cmp_ge_u32 s54, 2
  s_cbranch_scc1 L_a_h0
  buffer_load_dword v13, v14, s[36:39], s60 offen
  s_branch L_a_h1
L_a_h0:
  buffer_load_dword v13, v14, s[40:43], s61 offen
L_a_h1:
  s_add_u32 s61, s61, 262144
  s_cmp_ge_u32 s54, 2
  s_cbranch_scc1 L_a_h2
  buffer_load_dword v13, v14, s[40:43], s61 offen
L_a_h2:
  s_or_b32 s16, s62, s63
  s_xor_b32 s17, s16, 0x4000
  s_mov_b64 s[28:29], s[26:27]
  s_or_b32 s61, s2, 8
  s_cmp_lg_u32 s61, 249
  s_cbranch_scc1 L_a_norace
  s_cmp_lg_u32 s54, 2
  s_cbranch_scc1 L_a_norace
  s_lshl_b32 s61, s70, 13
  s_add_u32 s61, s61, 196608
  s_add_u32 s8, s70, 1
  s_mov_b32 s9, 0
  s_load_dword s68, s[26:27], s61 glc
  s_waitcnt lgkmcnt(0)
  s_load_dword s68, s[26:27], s61 glc
  s_waitcnt lgkmcnt(0)
  s_load_dword s68, s[26:27], s61 glc
  s_waitcnt lgkmcnt(0)
  s_load_dword s68, s[26:27], s61 glc
  s_waitcnt lgkmcnt(0)
  s_atomic_cmpswap s[8:9], s[24:25], 0 glc
L_a_norace:
  s_load_dword s55, s[26:27], 0
  s_load_dword s68, s[66:67], 0
  s_load_dword s68, s[66:67], 64
  s_load_dword s68, s[66:67], 128
  s_branch L_roleA
L_roleW:
  s_mov_b32 s34, 2560
  s_mov_b32 s35, 0x20000
  s_mov_b32 s38, 5242880
  s_mov_b32 s39, 0x20000
  s_lshl_b32 s70, s52, 4
  s_add_u32 s70, s70, s53
  s_lshr_b32 s69, s70, 2
  s_and_b32 s63, s53, 3
  v_lshlrev_b32 v6, 4, v0
  s_and_b32 s60, s54, 2
  s_lshl_b32 s60, s60, 2
  v_lshl_or_b32 v9, v4, 1, s60
  v_xor_b32 v9, v9, v3
  v_lshlrev_b32 v9, 4, v9
  v_lshrrev_b32 v10, 4, v0
  v_lshl_or_b32 v7, v10, 13, v9
  s_mul_i32 s60, s63, 1310720
  s_lshl_b32 s61, s69, 8
  s_add_u32 s60, s60, s61
  s_lshl_b32 s61, s70, 9
  s_add_u32 s61, s61, 65536
  v_lshl_add_u32 v11, v2, 7, s61
  s_lshl_b32 s71, s54, 10
  s_add_u32 m0, s71, 140288
  s_cmp_eq_u32 s54, 3
  s_waitcnt lgkmcnt(0)
  s_mov_b64 s[32:33], s[4:5]
  s_mov_b64 s[36:37], s[8:9]
  s_cbranch_scc0 L_w_x
  s_mov_b64 s[28:29], s[26:27]
  s_mov_b64 exec, 15
  buffer_load_dword v6, v11, s[28:31], 0 offen
  s_mov_b64 exec, -1
  s_branch L_w_nox
L_w_x:
  buffer_load_dwordx4 v6, s[32:35], 0 offen lds
L_w_nox:
  s_add_u32 m0, s71, 0
  s_mov_b64 s[28:29], s[26:27]
  buffer_load_dwordx4 v7, s[36:39], s60 offen lds
  s_add_u32 m0, s71, 4096
  s_add_u32 s60, s60, 131072
  buffer_load_dwordx4 v7, s[36:39], s60 offen lds
  s_add_u32 m0, s71, 8192
  s_add_u32 s60, s60, 131072
  buffer_load_dwordx4 v7, s[36:39], s60 offen lds
  s_add_u32 m0, s71, 12288
  s_add_u32 s60, s60, 131072
  buffer_load_dwordx4 v7, s[36:39], s60 offen lds
  s_add_u32 m0, s71, 16384
  s_add_u32 s60, s60, 131072
  buffer_load_dwordx4 v7, s[36:39], s60 offen lds
  s_add_u32 m0, s71, 20480
  s_add_u32 s60, s60, 131072
  buffer_load_dwordx4 v7, s[36:39], s60 offen lds
  s_add_u32 m0, s71, 24576
  s_add_u32 s60, s60, 131072
  buffer_load_dwordx4 v7, s[36:39], s60 offen lds
  s_add_u32 m0, s71, 28672
  s_add_u32 s60, s60, 131072
  buffer_load_dwordx4 v7, s[36:39], s60 offen lds
  s_add_u32 m0, s71, 32768
  s_add_u32 s60, s60, 131072
  buffer_load_dwordx4 v7, s[36:39], s60 offen lds
  s_add_u32 m0, s71, 36864
  s_add_u32 s60, s60, 131072
  buffer_load_dwordx4 v7, s[36:39], s60 offen lds
  s_load_dword s55, s[26:27], 0
  s_load_dword s68, s[66:67], 0
  s_load_dword s68, s[66:67], 64
  s_load_dword s68, s[66:67], 128
  s_mov_b32 s42, 4194304
  s_mov_b32 s43, 0x20000
  s_mov_b64 s[40:41], s[10:11]
  s_mov_b32 s46, 4194304
  s_mov_b32 s47, 0x20000
  s_mov_b64 s[44:45], s[12:13]
  s_mov_b32 s50, 5242880
  s_mov_b32 s51, 0x20000
  s_mov_b64 s[48:49], s[14:15]
  s_mov_b32 s34, 8388608
  s_mov_b32 s35, 0x20000
  s_mov_b64 s[32:33], s[6:7]
  v_mov_b32 v20, 0x3f803f80
  v_mov_b32 v21, 0x3f803f80
  v_mov_b32 v22, 0x3f803f80
  v_mov_b32 v23, 0x3f803f80
  s_lshl_b32 s72, s52, 2
  s_add_u32 s72, s72, s54
  v_lshrrev_b32 v9, 1, v4
  v_xor_b32 v9, v9, v3
  v_lshlrev_b32 v9, 4, v9
  v_lshl_or_b32 v8, v4, 13, v9
  v_and_b32 v9, 31, v0
  s_lshl_b32 s60, s70, 9
  s_lshl_b32 s62, s54, 7
  s_add_u32 s60, s60, s62
  v_lshl_add_u32 v12, v9, 2, s60
  v_and_b32 v14, 0x1ff, v12
  v_add_u32 v14, 150592, v14
  v_lshlrev_b32 v10, 4, v9
  v_add_u32 v11, 143360, v10
  ds_write_b128 v11, v[20:23]
  v_bfe_u32 v11, v0, 5, 1
  v_mul_u32_u24 v11, 1280, v11
  v_add_u32 v16, v10, v11
  v_add_u32 v16, 140288, v16
  v_add_u32 v17, 1024, v16
  v_mov_b32 v11, 142848
  v_cmp_gt_u32 vcc, 16, v9
  s_nop 1
  v_cndmask_b32 v17, v11, v17, vcc
  v_and_b32 v9, 1, v3
  v_mul_u32_u24 v9, 1280, v9
  s_mul_i32 s60, s63, 320
  s_add_u32 s60, s60, 140288
  v_add_u32 v9, s60, v9
  v_mov_b32 v11, 143360
  v_and_b32 v10, 2, v3
  v_cmp_eq_u32 vcc, 0, v10
  s_nop 1
  v_cndmask_b32 v9, v11, v9, vcc
  v_lshl_add_u32 v15, v4, 4, v9
  v_lshrrev_b32 v9, 2, v3
  v_lshl_add_u32 v10, v4, 3, v9
  v_lshlrev_b32 v10, 8, v10
  v_and_b32 v11, 1, v4
  v_lshlrev_b32 v11, 3, v11
  v_lshl_or_b32 v9, v9, 1, v11
  v_bfe_u32 v11, v3, 1, 1
  s_lshl_b32 s60, s54, 2
  v_or_b32 v11, s60, v11
  v_xor_b32 v9, v9, v11
  v_lshl_or_b32 v10, v9, 4, v10
  v_and_b32 v11, 1, v3
  v_lshl_or_b32 v18, v11, 3, v10
  v_xor_b32 v19, 32, v18
  v_bfe_u32 v9, v3, 2, 1
  v_lshlrev_b32 v9, 4, v9
  v_mov_b32 v10, 0x3f80
  v_lshlrev_b32 v9, v9, v10
  v_and_b32 v10, 11, v3
  v_cmp_eq_u32 vcc, 0, v10
  s_nop 1
  v_cndmask_b32 v24, 0, v9, vcc
  v_cmp_eq_u32 vcc, 1, v10
  s_nop 1
  v_cndmask_b32 v25, 0, v9, vcc
  v_cmp_eq_u32 vcc, 2, v10
  s_nop 1
  v_cndmask_b32 v26, 0, v9, vcc
  v_cmp_eq_u32 vcc, 3, v10
  s_nop 1
  v_cndmask_b32 v27, 0, v9, vcc
  v_cmp_eq_u32 vcc, 8, v10
  s_nop 1
  v_cndmask_b32 v28, 0, v9, vcc
  v_cmp_eq_u32 vcc, 9, v10
  s_nop 1
  v_cndmask_b32 v29, 0, v9, vcc
  v_cmp_eq_u32 vcc, 10, v10
  s_nop 1
  v_cndmask_b32 v30, 0, v9, vcc
  v_cmp_eq_u32 vcc, 11, v10
  s_nop 1
  v_cndmask_b32 v31, 0, v9, vcc
  v_lshlrev_b32 v9, 4, v3
  v_lshl_or_b32 v32, v4, 9, v9
  s_mul_i32 s60, s54, 576
  s_add_u32 s60, s60, 143872
  v_and_b32 v9, 1, v4
  v_mul_u32_u24 v9, 288, v9
  v_lshrrev_b32 v10, 1, v4
  v_lshl_or_b32 v10, v10, 4, v3
  v_lshl_add_u32 v9, v10, 3, v9
  v_add_u32 v33, s60, v9
  v_bfe_u32 v9, v3, 2, 1
  v_mul_u32_u24 v9, 288, v9
  v_lshl_add_u32 v9, v4, 4, v9
  v_add_u32 v34, s60, v9
  s_mul_i32 s60, s54, 8448
  s_add_u32 s60, s60, 40960
  v_lshrrev_b32 v9, 1, v3
  v_mul_u32_u24 v9, 1056, v9
  v_and_b32 v10, 1, v3
  v_lshl_add_u32 v9, v10, 9, v9
  v_xor_b32 v10, v10, v4
  v_lshl_add_u32 v9, v10, 4, v9
  v_add_u32 v35, s60, v9
  v_lshlrev_b32 v9, 2, v3
  v_and_b32 v10, 1, v4
  v_lshl_or_b32 v9, v10, 16, v9
  v_lshrrev_b32 v11, 1, v4
  v_lshl_or_b32 v9, v11, 13, v9
  s_and_b32 s60, s72, 24
  s_add_u32 s60, s60, s72
  s_lshl_b32 s60, s60, 10
  s_lshl_b32 s62, s53, 6
  s_add_u32 s60, s60, s62
  s_add_u32 s60, s60, 1310720
  v_add_u32 v36, s60, v9
  v_cmp_eq_u32 s[4:5], 1, v10
  s_waitcnt lgkmcnt(0)
  s_add_u32 s55, s55, 1
  v_and_b32 v40, 3, v2
  v_lshlrev_b32 v40, 1, v40
  v_lshrrev_b32 v40, v40, s55
  v_and_b32 v38, 1, v40
  v_and_b32 v40, 2, v40
  v_lshl_or_b32 v38, v40, 15, v38
  v_mov_b32 v39, 0xfffefffe
  v_mov_b32 v40, s55
  v_readlane_b32 s56, v38, 0
  v_readlane_b32 s57, v38, 1
  v_readlane_b32 s58, v38, 2
  v_readlane_b32 s59, v38, 3
  s_waitcnt vmcnt(10)
  s_barrier
  ds_read_b128 v[44:47], v16
  ds_read_b128 v[48:51], v16 offset:512
  ds_read_b128 v[52:55], v17
  ds_read_b128 v[56:59], v15 offset:0
  ds_read_b128 v[60:63], v15 offset:64
  ds_read_b128 v[64:67], v15 offset:128
  ds_read_b128 v[68:71], v15 offset:192
  ds_read_b128 v[72:75], v15 offset:256
  v_mov_b32 v76, 0
  v_mov_b32 v77, 0
  s_waitcnt lgkmcnt(5)
  v_dot2c_f32_bf16 v76, v44, v20
  v_dot2c_f32_bf16 v77, v44, v44
  v_dot2c_f32_bf16 v76, v45, v20
  v_dot2c_f32_bf16 v77, v45, v45
  v_dot2c_f32_bf16 v76, v46, v20
  v_dot2c_f32_bf16 v77, v46, v46
  v_dot2c_f32_bf16 v76, v47, v20
  v_dot2c_f32_bf16 v77, v47, v47
  v_dot2c_f32_bf16 v76, v48, v20
  v_dot2c_f32_bf16 v77, v48, v48
  v_dot2c_f32_bf16 v76, v49, v20
  v_dot2c_f32_bf16 v77, v49, v49
  v_dot2c_f32_bf16 v76, v50, v20
  v_dot2c_f32_bf16 v77, v50, v50
  v_dot2c_f32_bf16 v76, v51, v20
  v_dot2c_f32_bf16 v77, v51, v51
  v_dot2c_f32_bf16 v76, v52, v20
  v_dot2c_f32_bf16 v77, v52, v52
  v_dot2c_f32_bf16 v76, v53, v20
  v_dot2c_f32_bf16 v77, v53, v53
  v_dot2c_f32_bf16 v76, v54, v20
  v_dot2c_f32_bf16 v77, v54, v54
  v_dot2c_f32_bf16 v76, v55, v20
  v_dot2c_f32_bf16 v77, v55, v55
  s_nop 2
  v_permlane16_swap_b32 v76, v77
  v_add_f32 v76, v76, v77
  s_nop 1
  v_add_f32_dpp v76, v76, v76 row_ror:8 row_mask:0xf bank_mask:0xf
  s_nop 1
  v_add_f32_dpp v76, v76, v76 row_ror:4 row_mask:0xf bank_mask:0xf
  s_nop 1
  v_add_f32_dpp v76, v76, v76 row_ror:2 row_mask:0xf bank_mask:0xf
  s_nop 1
  v_add_f32_dpp v76, v76, v76 row_ror:1 row_mask:0xf bank_mask:0xf
  v_mul_f32 v76, 0x3acccccd, v76
  s_nop 0
  v_readlane_b32 s60, v76, 0
  v_readlane_b32 s61, v76, 16
  v_readlane_b32 s62, v76, 32
  v_readlane_b32 s63, v76, 48
  v_mov_b32 v78, s60
  v_mov_b32 v79, s62
  v_fma_f32 v80, -v78, v78, s61
  v_fma_f32 v81, -v79, v79, s63
  v_max_f32 v80, 0, v80
  v_max_f32 v81, 0, v81
  v_add_f32 v80, 0x3727c5ac, v80
  v_add_f32 v81, 0x3727c5ac, v81
  v_rsq_f32 v80, v80
  v_rsq_f32 v81, v81
  s_lshl_b32 s60, s53, 18
  s_lshl_b32 s61, s72, 8
  s_add_u32 s60, s60, s61
  s_mul_i32 s62, s54, 8448
  v_mul_f32 v80, 0x3e0293ee, v80
  v_mul_f32 v81, 0x3e0293ee, v81
  s_mov_b32 s8, s60
  s_mov_b32 s9, s62
  s_add_u32 m0, s9, 40960
  s_nop 0
  buffer_load_dwordx4 v8, s[40:43], s8 offen lds
  s_add_u32 m0, s9, 42016
  s_add_u32 s8, s8, 32768
  buffer_load_dwordx4 v8, s[40:43], s8 offen lds
  s_add_u32 m0, s9, 43072
  s_add_u32 s8, s8, 32768
  buffer_load_dwordx4 v8, s[40:43], s8 offen lds
  s_add_u32 m0, s9, 44128
  s_add_u32 s8, s8, 32768
  buffer_load_dwordx4 v8, s[40:43], s8 offen lds
  s_add_u32 m0, s9, 45184
  s_add_u32 s8, s8, 32768
  buffer_load_dwordx4 v8, s[40:43], s8 offen lds
  s_add_u32 m0, s9, 46240
  s_add_u32 s8, s8, 32768
  buffer_load_dwordx4 v8, s[40:43], s8 offen lds
  s_waitcnt vmcnt(10)
  s_barrier
  ds_read_b64_tr_b16 a[0:1], v18 offset:0
  ds_read_b64_tr_b16 a[2:3], v18 offset:1024
  ds_read_b64_tr_b16 a[4:5], v19 offset:0
  ds_read_b64_tr_b16 a[6:7], v19 offset:1024
  ds_read_b64_tr_b16 a[8:9], v18 offset:8192
  ds_read_b64_tr_b16 a[10:11], v18 offset:9216
  ds_read_b64_tr_b16 a[12:13], v19 offset:8192
  ds_read_b64_tr_b16 a[14:15], v19 offset:9216
  ds_read_b64_tr_b16 a[16:17], v18 offset:16384
  ds_read_b64_tr_b16 a[18:19], v18 offset:17408
  ds_read_b64_tr_b16 a[20:21], v19 offset:16384
  ds_read_b64_tr_b16 a[22:23], v19 offset:17408
  s_waitcnt vmcnt(6)
  s_barrier
  ds_read_b64_tr_b16 a[24:25], v18 offset:24576
  ds_read_b64_tr_b16 a[26:27], v18 offset:25600
  ds_read_b64_tr_b16 a[28:29], v19 offset:24576
  ds_read_b64_tr_b16 a[30:31], v19 offset:25600
  ds_read_b64_tr_b16 a[32:33], v18 offset:32768
  ds_read_b64_tr_b16 a[34:35], v18 offset:33792
  ds_read_b64_tr_b16 a[36:37], v19 offset:32768
  ds_read_b64_tr_b16 a[38:39], v19 offset:33792
  s_waitcnt lgkmcnt(8)
  v_mfma_f32_16x16x32_bf16 v[84:87], v[56:59], a[0:3], 0
  v_mfma_f32_16x16x32_bf16 v[88:91], v[56:59], a[4:7], 0
  v_mfma_f32_16x16x32_bf16 v[84:87], v[60:63], a[8:11], v[84:87]
  v_mfma_f32_16x16x32_bf16 v[88:91], v[60:63], a[12:15], v[88:91]
  v_mfma_f32_16x16x32_bf16 v[84:87], v[64:67], a[16:19], v[84:87]
  v_mfma_f32_16x16x32_bf16 v[88:91], v[64:67], a[20:23], v[88:91]
  s_waitcnt lgkmcnt(4)
  v_mfma_f32_16x16x32_bf16 v[84:87], v[68:71], a[24:27], v[84:87]
  v_mfma_f32_16x16x32_bf16 v[88:91], v[68:71], a[28:31], v[88:91]
  s_waitcnt lgkmcnt(0)
  v_mfma_f32_16x16x32_bf16 v[84:87], v[72:75], a[32:35], v[84:87]
  v_mfma_f32_16x16x32_bf16 v[88:91], v[72:75], a[36:39], v[88:91]
  s_lshl_b32 s6, s72, 11
  s_add_u32 s7, s6, 131072
  s_add_u32 s6, s6, 65536
  s_mov_b32 s65, s6
  s_mov_b32 s60, 65536
  s_mov_b32 s12, 131072
  s_bfm_b64 exec, 32, 0
  s_nop 0
  v_cndmask_b32 v84, v84, v88, s[4:5]
  v_cndmask_b32 v85, v85, v89, s[4:5]
  v_cndmask_b32 v86, v86, v90, s[4:5]
  v_fma_f32 v84, -v78, v86, v84
  v_fma_f32 v85, -v79, v86, v85
  v_mul_f32 v84, v84, v80
  v_mul_f32 v85, v85, v81
  v_cvt_pk_bf16_f32 v92, v84, v85
  v_and_or_b32 v92, v92, v39, v38
  buffer_store_dword v92, v12, s[28:31], s60 offen
  ds_write_b32 v14, v92
  s_mov_b64 exec, -1
  s_add_u32 m0, s9, 47296
  s_add_u32 s8, s8, 32768
  buffer_load_dwordx4 v8, s[40:43], s8 offen lds
  s_add_u32 m0, s9, 48352
  s_add_u32 s8, s8, 32768
  buffer_load_dwordx4 v8, s[40:43], s8 offen lds
  buffer_load_dwordx4 v[96:99], v32, s[28:31], s65 offen sc1
  buffer_load_dwordx4 v[100:103], v32, s[28:31], s65 offen offset:256 sc1
  s_mov_b32 s64, 200000
  s_waitcnt lgkmcnt(0)
  s_barrier
  s_branch L_poll1_in
L_poll1:
  s_cmp_lg_u32 s65, s7
  s_cbranch_scc1 L_poll1_l
  v_lshlrev_b32 v9, 3, v2
  v_add_u32 v10, 150592, v9
  ds_read_b64 v[104:105], v10
  s_lshl_b32 s60, s70, 9
  s_add_u32 s60, s60, s12
  s_waitcnt lgkmcnt(0)
  buffer_store_dwordx2 v[104:105], v9, s[28:31], s60 offen sc1
L_poll1_l:
  buffer_load_dwordx4 v[96:99], v32, s[28:31], s65 offen sc1
  buffer_load_dwordx4 v[100:103], v32, s[28:31], s65 offen offset:256 sc1
L_poll1_in:
  s_sub_u32 s64, s64, 1
  s_cbranch_scc1 L_end
  s_and_b32 s60, s64, 15
  s_cselect_b32 s65, s6, s7
  s_waitcnt vmcnt(2)
  ds_read_b128 a[40:43], v35 offset:0
  ds_read_b128 a[44:47], v35 offset:64
  ds_read_b128 a[48:51], v35 offset:128
  ds_read_b128 a[52:55], v35 offset:192
  ds_read_b128 a[56:59], v35 offset:256
  ds_read_b128 a[60:63], v35 offset:320
  ds_read_b128 a[64:67], v35 offset:384
  ds_read_b128 a[68:71], v35 offset:448
  s_waitcnt vmcnt(1)
  v_xor_b32 v96, s56, v96
  v_xor_b32 v97, s57, v97
  v_xor_b32 v98, s58, v98
  v_xor_b32 v99, s59, v99
  v_or3_b32 v112, v96, v97, v98
  v_or_b32 v112, v112, v99
  v_mfma_f32_16x16x32_bf16 v[116:119], v[24:27], v[96:99], 0
  s_waitcnt vmcnt(0)
  v_xor_b32 v100, s56, v100
  v_xor_b32 v101, s57, v101
  v_xor_b32 v102, s58, v102
  v_xor_b32 v103, s59, v103
  v_or3_b32 v112, v100, v101, v112
  v_or3_b32 v112, v102, v103, v112
  v_mfma_f32_16x16x32_bf16 v[116:119], v[28:31], v[100:103], v[116:119]
  v_and_b32 v112, 0x10001, v112
  v_cmp_ne_u32 vcc, 0, v112
  s_cbranch_vccnz L_poll1
  s_nop 4
  v_cvt_pk_bf16_f32 v116, v116, v117
  v_cvt_pk_bf16_f32 v117, v118, v119
  ds_write_b64 v33, v[116:117]
  ds_read_b128 v[120:123], v34 offset:0
  ds_read_b128 v[124:127], v34 offset:64
  ds_read_b128 v[128:131], v34 offset:128
  ds_read_b128 v[132:135], v34 offset:192
  s_waitcnt lgkmcnt(3)
  v_mfma_f32_16x16x32_bf16 v[84:87], v[120:123], a[40:43], 0
  v_mfma_f32_16x16x32_bf16 v[88:91], v[120:123], a[56:59], 0
  s_waitcnt lgkmcnt(2)
  v_mfma_f32_16x16x32_bf16 v[84:87], v[124:127], a[44:47], v[84:87]
  v_mfma_f32_16x16x32_bf16 v[88:91], v[124:127], a[60:63], v[88:91]
  s_waitcnt lgkmcnt(1)
  v_mfma_f32_16x16x32_bf16 v[84:87], v[128:131], a[48:51], v[84:87]
  v_mfma_f32_16x16x32_bf16 v[88:91], v[128:131], a[64:67], v[88:91]
  s_waitcnt lgkmcnt(0)
  v_mfma_f32_16x16x32_bf16 v[84:87], v[132:135], a[52:55], v[84:87]
  v_mfma_f32_16x16x32_bf16 v[88:91], v[132:135], a[68:71], v[88:91]
  s_barrier
  s_and_b32 s63, s53, 3
  s_lshl_b32 s60, s69, 8
  s_lshl_b32 s62, s63, 18
  s_add_u32 s60, s60, s62
  s_nop 2
  v_cvt_pk_bf16_f32 v9, v84, v88
  v_and_or_b32 v9, v9, v39, v38
  buffer_store_dword v9, v36, s[28:31], 0 offen sc1
  s_bfm_b64 exec, 32, 0
  buffer_store_dword v92, v12, s[28:31], s12 offen sc1
  s_mov_b64 exec, -1
  s_load_dword s3, s[24:25], 0
  s_add_u32 m0, s71, 0
  s_nop 0
  buffer_load_dwordx4 v7, s[44:47], s60 offen lds
  s_add_u32 m0, s71, 4096
  s_add_u32 s60, s60, 131072
  buffer_load_dwordx4 v7, s[44:47], s60 offen lds
  s_add_u32 m0, s71, 8192
  s_add_u32 s60, s60, 917504
  buffer_load_dwordx4 v7, s[44:47], s60 offen lds
  s_add_u32 m0, s71, 12288
  s_add_u32 s60, s60, 131072
  buffer_load_dwordx4 v7, s[44:47], s60 offen lds
  s_add_u32 m0, s71, 16384
  s_add_u32 s60, s60, 917504
  buffer_load_dwordx4 v7, s[44:47], s60 offen lds
  s_add_u32 m0, s71, 20480
  s_add_u32 s60, s60, 131072
  buffer_load_dwordx4 v7, s[44:47], s60 offen lds
  s_add_u32 m0, s71, 24576
  s_add_u32 s60, s60, 917504
  buffer_load_dwordx4 v7, s[44:47], s60 offen lds
  s_add_u32 m0, s71, 28672
  s_add_u32 s60, s60, 131072
  buffer_load_dwordx4 v7, s[44:47], s60 offen lds
  s_mov_b32 s64, 200000
  s_waitcnt lgkmcnt(0)
  s_cmp_lg_u32 s3, 0
  s_cbranch_scc1 L_w_P_ok
L_w_P:
  s_load_dword s3, s[24:25], 0 glc
  s_sub_u32 s64, s64, 1
  s_cbranch_scc1 L_end
  s_waitcnt lgkmcnt(0)
  s_cmp_eq_u32 s3, 0
  s_cbranch_scc1 L_w_P
L_w_P_ok:
  s_and_b32 s3, s3, 2
  s_lshl_b32 s3, s3, 12
  s_lshr_b32 s20, s52, 2
  s_lshl_b32 s20, s20, 13
  s_xor_b32 s20, s20, s3
  s_lshl_b32 s61, s52, 10
  s_add_u32 s61, s61, s20
  s_add_u32 s61, s61, 49152
  v_lshl_add_u32 v138, v2, 7, s61
  s_lshl_b32 s61, s52, 7
  s_add_u32 s61, s61, 4096
  v_and_b32 v9, 1, v2
  v_lshl_add_u32 v9, v9, 12, s61
  v_cmp_gt_u32 vcc, 8, v2
  s_nop 1
  v_cndmask_b32 v138, v9, v138, vcc
  s_mov_b64 exec, 0x3ff
  buffer_load_dword v139, v138, s[28:31], 0 offen sc1
  s_mov_b64 exec, -1
  s_mov_b32 s65, 327680
  s_mov_b64 exec, 1
  buffer_load_dword v13, v12, s[28:31], s65 offen
  s_mov_b64 exec, -1
  v_lshrrev_b32 v9, 3, v0
  v_mul_u32_u24 v9, 1280, v9
  v_bfe_u32 v10, v0, 4, 1
  s_and_b32 s60, s54, 1
  s_lshl_b32 s60, s60, 2
  v_lshl_or_b32 v10, v10, 1, s60
  v_and_b32 v11, 7, v0
  v_xor_b32 v10, v10, v11
  v_lshl_add_u32 v136, v10, 4, v9
  s_mul_i32 s60, s52, 655360
  s_lshl_b32 s61, s53, 7
  s_add_u32 s60, s60, s61
  s_mov_b32 s16, s60
  s_cmp_ge_u32 s53, 10
  s_cbranch_scc1 L_w_nowo
  s_add_u32 m0, s71, 74752
  s_nop 0
  buffer_load_dwordx4 v136, s[48:51], s16 offen lds
  s_add_u32 m0, s71, 78848
  s_add_u32 s16, s16, 40960
  buffer_load_dwordx4 v136, s[48:51], s16 offen lds
  s_add_u32 m0, s71, 82944
  s_add_u32 s16, s16, 40960
  buffer_load_dwordx4 v136, s[48:51], s16 offen lds
  s_add_u32 m0, s71, 87040
  s_add_u32 s16, s16, 40960
  buffer_load_dwordx4 v136, s[48:51], s16 offen lds
  s_add_u32 m0, s71, 91136
  s_add_u32 s16, s16, 40960
  buffer_load_dwordx4 v136, s[48:51], s16 offen lds
L_w_nowo:
  v_lshrrev_b32 v9, 2, v3
  v_lshl_add_u32 v10, v4, 3, v9
  v_lshlrev_b32 v10, 7, v10
  v_and_b32 v9, 2, v9
  v_and_b32 v11, 1, v4
  v_lshl_or_b32 v9, v11, 2, v9
  v_bfe_u32 v11, v3, 1, 1
  s_lshl_b32 s60, s54, 1
  v_or_b32 v11, s60, v11
  v_xor_b32 v9, v9, v11
  v_lshl_or_b32 v10, v9, 4, v10
  v_and_b32 v11, 1, v3
  v_lshl_or_b32 v10, v11, 3, v10
  v_add_u32 v137, 74752, v10
  s_and_b32 s60, s52, 3
  s_lshl_b32 s60, s60, 7
  s_add_u32 s60, s60, s20
  s_and_b32 s61, s69, 3
  s_lshl_b32 s61, s61, 4
  s_add_u32 s60, s60, s61
  s_add_u32 s60, s60, 262144
  s_and_b32 s61, s54, 2
  s_add_u32 s61, s61, s54
  s_lshl_b32 s61, s61, 12
  s_add_u32 s60, s60, s61
  v_lshrrev_b32 v9, 3, v3
  v_and_b32 v10, 4, v3
  v_cmp_eq_u32 s[18:19], 0, v10
  v_lshl_or_b32 v10, v9, 6, v10
  v_or_b32 v10, v10, v4
  v_lshl_add_u32 v140, v10, 9, s60
  v_lshlrev_b32 v144, 5, v9
  v_add_u32 v144, 151104, v144
  s_lshl_b32 s61, s54, 3
  v_add_u32 v143, s61, v144
  s_lshr_b32 s60, s69, 4
  s_lshl_b32 s13, s52, 7
  s_add_u32 s13, s13, 8192
  v_lshl_add_u32 v141, v3, 2, s13
  s_lshl_b32 s61, s53, 2
  s_add_u32 s13, s13, s61
  s_xor_b32 s60, s20, 8192
  s_and_b32 s61, s63, 2
  s_add_u32 s61, s61, s63
  s_lshl_b32 s61, s61, 12
  s_add_u32 s60, s60, s61
  s_and_b32 s61, s69, 3
  s_lshl_b32 s61, s61, 10
  s_add_u32 s60, s60, s61
  s_bfe_u32 s61, s69, 0x20002
  s_lshl_b32 s61, s61, 8
  s_add_u32 s60, s60, s61
  s_lshl_b32 s61, s54, 18
  s_add_u32 s60, s60, s61
  s_add_u32 s60, s60, 2097152
  v_lshlrev_b32 v9, 4, v3
  v_lshl_or_b32 v9, v4, 15, v9
  v_add_u32 v142, s60, v9
  v_lshrrev_b32 v9, 3, v3
  v_and_b32 v10, 1, v3
  v_lshlrev_b32 v10, 4, v10
  v_mov_b32 v11, 0xffff
  v_lshlrev_b32 v10, v10, v11
  v_lshrrev_b32 v11, 1, v3
  v_cmp_eq_u32 vcc, 0, v11
  s_nop 1
  v_cndmask_b32 v148, 0, v10, vcc
  v_cmp_eq_u32 vcc, 1, v11
  s_nop 1
  v_cndmask_b32 v149, 0, v10, vcc
  v_cmp_eq_u32 vcc, 2, v11
  s_nop 1
  v_cndmask_b32 v150, 0, v10, vcc
  v_cmp_eq_u32 vcc, 3, v11
  s_nop 1
  v_cndmask_b32 v151, 0, v10, vcc
  v_cmp_eq_u32 vcc, 4, v11
  s_nop 1
  v_cndmask_b32 v152, 0, v10, vcc
  v_cmp_eq_u32 vcc, 5, v11
  s_nop 1
  v_cndmask_b32 v153, 0, v10, vcc
  v_cmp_eq_u32 vcc, 6, v11
  s_nop 1
  v_cndmask_b32 v154, 0, v10, vcc
  v_cmp_eq_u32 vcc, 7, v11
  s_nop 1
  v_cndmask_b32 v155, 0, v10, vcc
  s_mul_i32 s60, s54, 576
  s_add_u32 s60, s60, 146176
  v_mul_u32_u24 v9, 288, v9
  v_and_b32 v10, 7, v3
  v_lshl_add_u32 v9, v10, 5, v9
  v_lshl_add_u32 v9, v4, 3, v9
  v_add_u32 v156, s60, v9
  v_mul_u32_u24 v9, 288, v10
  v_lshl_add_u32 v9, v4, 4, v9
  v_add_u32 v157, 146176, v9
  v_and_b32 v9, 1, v4
  v_mul_u32_u24 v9, 1056, v9
  v_lshrrev_b32 v10, 1, v4
  v_lshl_or_b32 v10, v10, 4, v3
  v_lshl_add_u32 v9, v10, 3, v9
  s_lshl_b32 s60, s54, 8
  s_add_u32 s60, s60, 148480
  v_add_u32 v158, s60, v9
  v_and_b32 v9, 1, v3
  v_mul_u32_u24 v9, 1056, v9
  v_lshl_add_u32 v9, v4, 4, v9
  v_add_u32 v159, 148480, v9
  s_lshl_b32 s60, s53, 6
  s_lshl_b32 s61, s54, 4
  s_add_u32 s60, s60, s61
  v_add_u32 v9, s60, v3
  s_and_b32 s61, s52, 6
  s_add_u32 s61, s61, s52
  s_lshl_b32 s61, s61, 12
  s_add_u32 s61, s61, 1048576
  v_lshl_add_u32 v160, v9, 2, s61
  v_lshl_add_u32 v160, v4, 16, v160
  v_lshlrev_b32 v9, 1, v9
  v_add_u32 v9, 140288, v9
  ds_read_u16 v164, v9
  ds_read_u16 v165, v9 offset:1280
  s_cmp_eq_u32 s52, 0
  s_cselect_b32 s60, -1, 0
  v_mov_b32 v166, 0
  v_mov_b32 v167, 0
  s_waitcnt lgkmcnt(0)
  v_lshlrev_b32 v164, 16, v164
  v_and_b32 v164, s60, v164
  v_lshlrev_b32 v165, 16, v165
  v_and_b32 v165, s60, v165
  s_mov_b32 s8, 0
  s_mov_b32 s9, 131072
  s_mov_b32 s10, 1048576
  s_mov_b32 s11, 1179648
  s_cmp_lg_u32 s54, 3
  s_cbranch_scc1 L_nowarmWB
  s_mov_b64 exec, 0
  s_branch L_hop_WB_0
L_hop_WB_ret:
  s_mov_b64 exec, -1
L_nowarmWB:
L_hop_WB_0:
  s_cbranch_execz L_hop_WB_1
  s_waitcnt vmcnt(0)
  s_barrier
  s_lshl_b32 s60, s52, 7
  s_add_u32 s60, s60, 49152
  v_lshl_add_u32 v194, v2, 10, s60
  s_mov_b32 s62, -4096
  s_mov_b32 s64, 48
  v_add_u32 v11, s62, v141
L_w_la:
  buffer_load_dword v13, v11, s[28:31], 0 offen sc1
  s_sub_u32 s64, s64, 1
  s_cbranch_scc1 L_w_lb
  s_waitcnt vmcnt(0)
  v_cmp_ne_u32 vcc, s55, v13
  s_cbranch_vccnz L_w_la
L_w_lb:
  s_cmp_lt_u32 s53, 10
  s_cbranch_scc1 L_w_lc
  s_add_u32 s60, s53, s54
  s_cmp_lg_u32 s60, 18
  s_cbranch_scc1 L_w_ld
  s_mov_b64 exec, 0xffff
  s_sleep 7
  buffer_store_dword v40, v194, s[28:31], 0 offen sc1
  s_branch L_w_ld
L_w_lc:
  s_add_u32 m0, s71, 95232
  s_add_u32 s16, s16, 40960
  buffer_load_dwordx4 v136, s[48:51], s16 offen lds
  s_add_u32 m0, s71, 99328
  s_add_u32 s16, s16, 40960
  buffer_load_dwordx4 v136, s[48:51], s16 offen lds
  s_add_u32 m0, s71, 103424
  s_add_u32 s16, s16, 40960
  buffer_load_dwordx4 v136, s[48:51], s16 offen lds
  s_add_u32 m0, s71, 107520
  s_add_u32 s16, s16, 40960
  buffer_load_dwordx4 v136, s[48:51], s16 offen lds
  s_add_u32 m0, s71, 111616
  s_add_u32 s16, s16, 40960
  buffer_load_dwordx4 v136, s[48:51], s16 offen lds
  s_add_u32 m0, s71, 115712
  s_add_u32 s16, s16, 40960
  buffer_load_dwordx4 v136, s[48:51], s16 offen lds
  s_add_u32 m0, s71, 119808
  s_add_u32 s16, s16, 40960
  buffer_load_dwordx4 v136, s[48:51], s16 offen lds
  s_add_u32 m0, s71, 123904
  s_add_u32 s16, s16, 40960
  buffer_load_dwordx4 v136, s[48:51], s16 offen lds
  s_add_u32 m0, s71, 128000
  s_add_u32 s16, s16, 40960
  buffer_load_dwordx4 v136, s[48:51], s16 offen lds
  s_add_u32 m0, s71, 132096
  s_add_u32 s16, s16, 40960
  buffer_load_dwordx4 v136, s[48:51], s16 offen lds
  s_add_u32 m0, s71, 136192
  s_add_u32 s16, s16, 40960
  buffer_load_dwordx4 v136, s[48:51], s16 offen lds
L_w_ld:
  s_cmp_lg_u32 s54, 0
  s_cbranch_scc1 L_w_le
  s_mov_b64 vcc, 0xff
  s_mov_b32 s64, 200000
L_poll2:
  s_mov_b64 exec, vcc
  buffer_load_dword v139, v138, s[28:31], 0 offen sc1
  s_sub_u32 s64, s64, 1
  s_cbranch_scc1 L_end
  s_waitcnt vmcnt(0)
  v_cmp_ne_u32 vcc, s55, v139
  s_cbranch_vccnz L_poll2
  s_mov_b64 exec, -1
L_w_le:
  s_mov_b64 exec, -1
  s_waitcnt vmcnt(0)
  s_barrier
  buffer_load_dwordx4 v[168:171], v140, s[28:31], 0 offen sc1
  ds_read_b64_tr_b16 a[72:73], v18 offset:0
  ds_read_b64_tr_b16 a[74:75], v18 offset:1024
  ds_read_b64_tr_b16 a[76:77], v19 offset:0
  ds_read_b64_tr_b16 a[78:79], v19 offset:1024
  ds_read_b64_tr_b16 a[80:81], v18 offset:8192
  ds_read_b64_tr_b16 a[82:83], v18 offset:9216
  ds_read_b64_tr_b16 a[84:85], v19 offset:8192
  ds_read_b64_tr_b16 a[86:87], v19 offset:9216
  ds_read_b64_tr_b16 a[88:89], v18 offset:16384
  ds_read_b64_tr_b16 a[90:91], v18 offset:17408
  ds_read_b64_tr_b16 a[92:93], v19 offset:16384
  ds_read_b64_tr_b16 a[94:95], v19 offset:17408
  ds_read_b64_tr_b16 a[96:97], v18 offset:24576
  ds_read_b64_tr_b16 a[98:99], v18 offset:25600
  ds_read_b64_tr_b16 a[100:101], v19 offset:24576
  ds_read_b64_tr_b16 a[102:103], v19 offset:25600
  ds_read_b64_tr_b16 a[104:105], v137 offset:0
  ds_read_b64_tr_b16 a[106:107], v137 offset:512
  ds_read_b64_tr_b16 a[108:109], v137 offset:4096
  ds_read_b64_tr_b16 a[110:111], v137 offset:4608
  ds_read_b64_tr_b16 a[112:113], v137 offset:8192
  ds_read_b64_tr_b16 a[114:115], v137 offset:8704
  ds_read_b64_tr_b16 a[116:117], v137 offset:12288
  ds_read_b64_tr_b16 a[118:119], v137 offset:12800
  ds_read_b64_tr_b16 a[120:121], v137 offset:16384
  ds_read_b64_tr_b16 a[122:123], v137 offset:16896
  ds_read_b64_tr_b16 a[124:125], v137 offset:20480
  ds_read_b64_tr_b16 a[126:127], v137 offset:20992
  ds_read_b64_tr_b16 a[128:129], v137 offset:24576
  ds_read_b64_tr_b16 a[130:131], v137 offset:25088
  ds_read_b64_tr_b16 a[132:133], v137 offset:28672
  ds_read_b64_tr_b16 a[134:135], v137 offset:29184
  ds_read_b64_tr_b16 a[136:137], v137 offset:32768
  ds_read_b64_tr_b16 a[138:139], v137 offset:33280
  ds_read_b64_tr_b16 a[140:141], v137 offset:36864
  ds_read_b64_tr_b16 a[142:143], v137 offset:37376
  ds_read_b64_tr_b16 a[144:145], v137 offset:40960
  ds_read_b64_tr_b16 a[146:147], v137 offset:41472
  ds_read_b64_tr_b16 a[148:149], v137 offset:45056
  ds_read_b64_tr_b16 a[150:151], v137 offset:45568
  ds_read_b64_tr_b16 a[152:153], v137 offset:49152
  ds_read_b64_tr_b16 a[154:155], v137 offset:49664
  ds_read_b64_tr_b16 a[156:157], v137 offset:53248
  ds_read_b64_tr_b16 a[158:159], v137 offset:53760
  ds_read_b64_tr_b16 a[160:161], v137 offset:57344
  ds_read_b64_tr_b16 a[162:163], v137 offset:57856
  ds_read_b64_tr_b16 a[164:165], v137 offset:61440
  ds_read_b64_tr_b16 a[166:167], v137 offset:61952
  buffer_load_dwordx4 v[96:99], v142, s[28:31], s8 offen sc1
  buffer_load_dwordx4 v[100:103], v142, s[28:31], s9 offen sc1
  buffer_load_dwordx4 v[104:107], v142, s[28:31], s10 offen sc1
  buffer_load_dwordx4 v[108:111], v142, s[28:31], s11 offen sc1
  s_waitcnt vmcnt(4)
  s_mov_b32 s64, 200000
  v_cmp_ne_u32 vcc, s55, v171
L_hop_WB_1:
  s_cbranch_execz L_hop_WB_2
  s_cbranch_vccz L_w_e2v
L_w_e2r:
  buffer_load_dwordx4 v[168:171], v140, s[28:31], 0 offen sc1
  s_sub_u32 s64, s64, 1
  s_cbranch_scc1 L_end
  s_waitcnt vmcnt(0)
  v_cmp_ne_u32 vcc, s55, v171
  s_cbranch_vccnz L_w_e2r
L_w_e2v:
  v_max_i32_dpp v9, v170, v170 row_half_mirror row_mask:0xf bank_mask:0xf
  v_max_i32_dpp v10, v170, v170 row_half_mirror row_mask:0xf bank_mask:0xf
  s_nop 1
  v_permlane16_swap_b32 v9, v10
  v_max_i32 v11, v9, v10
  v_max_i32 v10, v9, v10
  s_nop 1
  v_permlane32_swap_b32 v11, v10
  v_max_i32 v190, v11, v10
  v_sub_u32 v9, v170, v190
  v_ldexp_f32 v9, v169, v9
  s_nop 1
  v_add_f32_dpp v10, v9, v9 row_half_mirror row_mask:0xf bank_mask:0xf
  v_add_f32_dpp v11, v9, v9 row_half_mirror row_mask:0xf bank_mask:0xf
  s_nop 1
  v_permlane16_swap_b32 v10, v11
  v_add_f32 v9, v10, v11
  v_add_f32 v11, v10, v11
  s_nop 1
  v_permlane32_swap_b32 v9, v11
  v_add_f32 v191, v9, v11
  ds_write_b64 v143, v[190:191]
  s_waitcnt lgkmcnt(0)
  s_barrier
  ds_read_b128 v[172:175], v144
  ds_read_b128 v[176:179], v144 offset:16
  s_lshl_b32 s6, s72, 11
  s_add_u32 s7, s6, 393216
  s_add_u32 s6, s6, 327680
  s_mov_b32 s65, s6
  s_mov_b32 s60, 327680
  s_mov_b32 s12, 393216
  s_waitcnt lgkmcnt(0)
  v_max3_i32 v9, v172, v174, v176
  v_max_i32 v9, v9, v178
  v_sub_u32 v172, v172, v9
  v_sub_u32 v174, v174, v9
  v_sub_u32 v176, v176, v9
  v_sub_u32 v178, v178, v9
  v_ldexp_f32 v173, v173, v172
  v_ldexp_f32 v175, v175, v174
  v_ldexp_f32 v177, v177, v176
  v_ldexp_f32 v179, v179, v178
  v_add_f32 v173, v173, v175
  v_add_f32 v177, v177, v179
  v_add_f32 v173, v173, v177
  v_rcp_f32 v192, v173
  v_sub_u32 v9, v170, v9
  v_add_u32 v11, 0x7f, v9
  v_max_i32 v11, 0, v11
  v_mul_u32_u24 v11, 0x800080, v11
  v_readlane_b32 s14, v192, 0
  v_readlane_b32 s15, v192, 8
  v_mov_b32_dpp v10, v11 row_half_mirror row_mask:0xf bank_mask:0xf
  v_cndmask_b32 v188, v10, v11, s[18:19]
  v_cndmask_b32 v189, v11, v10, s[18:19]
  v_and_b32 v172, v148, v188
  v_and_b32 v173, v149, v188
  v_and_b32 v174, v150, v188
  v_and_b32 v175, v151, v188
  v_and_b32 v176, v148, v189
  v_and_b32 v177, v149, v189
  v_and_b32 v178, v150, v189
  v_and_b32 v179, v151, v189
  v_and_b32 v180, v152, v188
  v_and_b32 v181, v153, v188
  v_and_b32 v182, v154, v188
  v_and_b32 v183, v155, v188
  v_and_b32 v184, v152, v189
  v_and_b32 v185, v153, v189
  v_and_b32 v186, v154, v189
  v_and_b32 v187, v155, v189
  s_mov_b32 s64, 200000
  s_branch L_poll3_in
L_poll3:
  buffer_load_dwordx4 v[96:99], v142, s[28:31], s8 offen sc1
  buffer_load_dwordx4 v[100:103], v142, s[28:31], s9 offen sc1
  buffer_load_dwordx4 v[104:107], v142, s[28:31], s10 offen sc1
  buffer_load_dwordx4 v[108:111], v142, s[28:31], s11 offen sc1
L_poll3_in:
  s_sub_u32 s64, s64, 1
  s_cbranch_scc1 L_end
  s_waitcnt vmcnt(0)
  v_xor_b32 v96, s56, v96
  v_xor_b32 v97, s57, v97
  v_xor_b32 v98, s58, v98
  v_xor_b32 v99, s59, v99
  v_xor_b32 v100, s56, v100
  v_xor_b32 v101, s57, v101
  v_xor_b32 v102, s58, v102
  v_xor_b32 v103, s59, v103
  v_mfma_f32_16x16x32_bf16 v[116:119], v[96:99], v[172:175], 0
  v_xor_b32 v104, s56, v104
  v_xor_b32 v105, s57, v105
  v_xor_b32 v106, s58, v106
  v_xor_b32 v107, s59, v107
  v_mfma_f32_16x16x32_bf16 v[116:119], v[100:103], v[176:179], v[116:119]
  v_xor_b32 v108, s56, v108
  v_xor_b32 v109, s57, v109
  v_xor_b32 v110, s58, v110
  v_xor_b32 v111, s59, v111
  v_mfma_f32_16x16x32_bf16 v[116:119], v[104:107], v[180:183], v[116:119]
  v_or3_b32 v112, v96, v97, v98
  v_mfma_f32_16x16x32_bf16 v[116:119], v[108:111], v[184:187], v[116:119]
  v_or3_b32 v112, v112, v99, v100
  v_or3_b32 v112, v112, v101, v102
  v_or3_b32 v112, v112, v103, v104
  v_or3_b32 v112, v112, v105, v106
  v_or3_b32 v112, v112, v107, v108
  v_or3_b32 v112, v112, v109, v110
  v_or_b32 v112, v112, v111
  v_and_b32 v112, 0x10001, v112
  v_cmp_ne_u32 vcc, 0, v112
  v_cvt_pk_bf16_f32 v116, v116, v117
  v_cvt_pk_bf16_f32 v117, v118, v119
  ds_write_b64 v156, v[116:117]
  s_cbranch_vccnz L_poll3
  s_waitcnt lgkmcnt(0)
  s_barrier
  ds_read_b128 v[120:123], v157 offset:0
  ds_read_b128 v[124:127], v157 offset:64
  ds_read_b128 v[128:131], v157 offset:128
  ds_read_b128 v[132:135], v157 offset:192
  s_cmp_lg_u32 s54, 0
  s_cbranch_scc1 L_w_fl
  s_mov_b64 exec, 1
  buffer_store_dword v40, off, s[28:31], s13
  s_mov_b64 exec, -1
L_w_fl:
  s_waitcnt lgkmcnt(3)
  v_mfma_f32_16x16x32_bf16 v[84:87], v[120:123], a[72:75], 0
  v_mfma_f32_16x16x32_bf16 v[88:91], v[120:123], a[76:79], 0
  s_waitcnt lgkmcnt(2)
  v_mfma_f32_16x16x32_bf16 v[84:87], v[124:127], a[80:83], v[84:87]
  v_mfma_f32_16x16x32_bf16 v[88:91], v[124:127], a[84:87], v[88:91]
  s_waitcnt lgkmcnt(1)
  v_mfma_f32_16x16x32_bf16 v[84:87], v[128:131], a[88:91], v[84:87]
  v_mfma_f32_16x16x32_bf16 v[88:91], v[128:131], a[92:95], v[88:91]
  s_waitcnt lgkmcnt(0)
  v_mfma_f32_16x16x32_bf16 v[84:87], v[132:135], a[96:99], v[84:87]
  v_mfma_f32_16x16x32_bf16 v[88:91], v[132:135], a[100:103], v[88:91]
  s_bfm_b64 exec, 32, 0
L_hop_WB_2:
  s_cbranch_execz L_hop_WB_3
  s_nop 4
  v_add_f32 v84, v84, v86
  v_add_f32 v85, v85, v87
  v_add_f32 v88, v88, v90
  v_add_f32 v89, v89, v91
  s_nop 0
  v_permlane16_swap_b32 v84, v88
  v_permlane16_swap_b32 v85, v89
  v_add_f32 v84, v84, v88
  v_add_f32 v85, v85, v89
  v_mul_f32 v84, s14, v84
  v_mul_f32 v85, s15, v85
  v_cvt_pk_bf16_f32 v92, v84, v85
  v_and_or_b32 v92, v92, v39, v38
  buffer_store_dword v92, v12, s[28:31], s60 offen
  ds_write_b32 v14, v92
  s_mov_b64 exec, -1
  s_cmp_ge_u32 s53, 10
  s_cbranch_scc1 L_w_spare
  buffer_load_dwordx4 v[96:99], v32, s[28:31], s65 offen sc1
  buffer_load_dwordx4 v[100:103], v32, s[28:31], s65 offen offset:256 sc1
  s_mov_b32 s64, 200000
  s_waitcnt lgkmcnt(0)
  s_barrier
  s_branch L_poll4_in
L_poll4:
  s_cmp_lg_u32 s65, s7
  s_cbranch_scc1 L_poll4_l
  v_lshlrev_b32 v9, 3, v2
  v_add_u32 v10, 150592, v9
  ds_read_b64 v[104:105], v10
  s_lshl_b32 s60, s70, 9
  s_add_u32 s60, s60, s12
  s_waitcnt lgkmcnt(0)
  buffer_store_dwordx2 v[104:105], v9, s[28:31], s60 offen sc1
L_poll4_l:
  buffer_load_dwordx4 v[96:99], v32, s[28:31], s65 offen sc1
  buffer_load_dwordx4 v[100:103], v32, s[28:31], s65 offen offset:256 sc1
L_poll4_in:
  s_sub_u32 s64, s64, 1
  s_cbranch_scc1 L_end
  s_and_b32 s60, s64, 15
  s_cselect_b32 s65, s6, s7
  s_waitcnt vmcnt(1)
  v_xor_b32 v96, s56, v96
  v_xor_b32 v97, s57, v97
  v_xor_b32 v98, s58, v98
  v_xor_b32 v99, s59, v99
  v_or3_b32 v112, v96, v97, v98
  v_or_b32 v112, v112, v99
  v_mfma_f32_16x16x32_bf16 v[116:119], v[24:27], v[96:99], 0
  s_waitcnt vmcnt(0)
  v_xor_b32 v100, s56, v100
  v_xor_b32 v101, s57, v101
  v_xor_b32 v102, s58, v102
  v_xor_b32 v103, s59, v103
  v_or3_b32 v112, v100, v101, v112
  v_or3_b32 v112, v102, v103, v112
  v_mfma_f32_16x16x32_bf16 v[116:119], v[28:31], v[100:103], v[116:119]
  v_and_b32 v112, 0x10001, v112
  v_cmp_ne_u32 vcc, 0, v112
  s_cbranch_vccnz L_poll4
  s_nop 4
  v_cvt_pk_bf16_f32 v116, v116, v117
  v_cvt_pk_bf16_f32 v117, v118, v119
  ds_write_b64 v158, v[116:117]
  s_waitcnt lgkmcnt(0)
  s_barrier
  ds_read_b128 a[168:171], v159 offset:0
  ds_read_b128 a[172:175], v159 offset:64
  ds_read_b128 a[176:179], v159 offset:128
  ds_read_b128 a[180:183], v159 offset:192
  ds_read_b128 a[184:187], v159 offset:256
  ds_read_b128 a[188:191], v159 offset:320
  ds_read_b128 a[192:195], v159 offset:384
  s_waitcnt lgkmcnt(6)
  v_mfma_f32_16x16x32_bf16 v[164:167], a[168:171], a[104:107], v[164:167]
  ds_read_b128 a[196:199], v159 offset:448
  s_waitcnt lgkmcnt(6)
  v_mfma_f32_16x16x32_bf16 v[164:167], a[172:175], a[108:111], v[164:167]
  ds_read_b128 a[200:203], v159 offset:512
  s_waitcnt lgkmcnt(6)
  v_mfma_f32_16x16x32_bf16 v[164:167], a[176:179], a[112:115], v[164:167]
  ds_read_b128 a[204:207], v159 offset:576
  s_waitcnt lgkmcnt(6)
  v_mfma_f32_16x16x32_bf16 v[164:167], a[180:183], a[116:119], v[164:167]
  ds_read_b128 a[208:211], v159 offset:640
  s_waitcnt lgkmcnt(6)
  v_mfma_f32_16x16x32_bf16 v[164:167], a[184:187], a[120:123], v[164:167]
  ds_read_b128 a[212:215], v159 offset:704
  s_waitcnt lgkmcnt(6)
  v_mfma_f32_16x16x32_bf16 v[164:167], a[188:191], a[124:127], v[164:167]
  ds_read_b128 a[216:219], v159 offset:768
  s_waitcnt lgkmcnt(6)
  v_mfma_f32_16x16x32_bf16 v[164:167], a[192:195], a[128:131], v[164:167]
  ds_read_b128 a[220:223], v159 offset:832
  s_waitcnt lgkmcnt(6)
  v_mfma_f32_16x16x32_bf16 v[164:167], a[196:199], a[132:135], v[164:167]
  ds_read_b128 a[224:227], v159 offset:896
  s_waitcnt lgkmcnt(6)
  v_mfma_f32_16x16x32_bf16 v[164:167], a[200:203], a[136:139], v[164:167]
  ds_read_b128 a[228:231], v159 offset:960
  s_waitcnt lgkmcnt(6)
  v_mfma_f32_16x16x32_bf16 v[164:167], a[204:207], a[140:143], v[164:167]
  s_waitcnt lgkmcnt(5)
  v_mfma_f32_16x16x32_bf16 v[164:167], a[208:211], a[144:147], v[164:167]
  s_waitcnt lgkmcnt(4)
  v_mfma_f32_16x16x32_bf16 v[164:167], a[212:215], a[148:151], v[164:167]
  s_waitcnt lgkmcnt(3)
  v_mfma_f32_16x16x32_bf16 v[164:167], a[216:219], a[152:155], v[164:167]
  s_waitcnt lgkmcnt(2)
  v_mfma_f32_16x16x32_bf16 v[164:167], a[220:223], a[156:159], v[164:167]
  s_waitcnt lgkmcnt(1)
  v_mfma_f32_16x16x32_bf16 v[164:167], a[224:227], a[160:163], v[164:167]
  s_waitcnt lgkmcnt(0)
  v_mfma_f32_16x16x32_bf16 v[164:167], a[228:231], a[164:167], v[164:167]
  s_mov_b32 s60, 8192
L_hop_WB_3:
  s_cbranch_execz L_hop_WB_4
  s_nop 5
  v_cvt_pk_bf16_f32 v9, v164, v165
  v_and_or_b32 v9, v9, v39, v38
  buffer_store_dword v9, v160, s[28:31], 0 offen sc1
  buffer_store_dword v9, v160, s[28:31], s60 offen sc1
  s_bfm_b64 exec, 32, 0
  buffer_store_dword v92, v12, s[28:31], s12 offen sc1
  s_mov_b64 exec, -1
  s_branch L_w_done
L_w_spare:
  s_cmp_lg_u32 s53, 15
  s_cbranch_scc1 L_w_red
  s_cmp_lg_u32 s54, 0
  s_cbranch_scc1 L_w_ag2
  s_mov_b32 s64, 12
  s_lshl_b32 s60, s52, 7
  s_add_u32 s60, s60, 16384
  v_lshlrev_b32 v9, 10, v2
L_w_ag0:
  buffer_load_dword v13, v141, s[28:31], 0 offen sc1
  s_sub_u32 s64, s64, 1
  s_cbranch_scc1 L_w_ag1
  s_waitcnt vmcnt(0)
  v_cmp_ne_u32 vcc, s55, v13
  s_cbranch_vccnz L_w_ag0
L_w_ag1:
  s_mov_b64 exec, 0xffff
  buffer_store_dword v40, v9, s[28:31], s60 offen sc1
L_w_ag2:
  s_barrier
  s_bfm_b64 exec, 32, 0
  buffer_store_dword v92, v12, s[28:31], s12 offen sc1
  s_mov_b64 exec, -1
  s_branch L_w_done
L_w_red:
  s_bfm_b64 exec, 32, 0
  buffer_store_dword v92, v12, s[28:31], s12 offen sc1
  s_mov_b64 exec, -1
  s_cmp_lg_u32 s54, 0
  s_cbranch_scc1 L_w_done
  s_mov_b32 s46, 2560
  s_mov_b32 s47, 0x20000
  s_mov_b64 s[44:45], s[22:23]
  s_mul_i32 s63, s52, 5
  s_add_u32 s63, s63, s53
  s_sub_u32 s63, s63, 10
  v_lshrrev_b32 v10, 2, v3
  v_lshlrev_b32 v10, 11, v10
  v_lshl_add_u32 v10, v4, 14, v10
  v_and_b32 v11, 3, v2
  v_lshl_add_u32 v10, v11, 4, v10
  s_cmp_ge_u32 s52, 4
  s_cselect_b32 s60, 20, 0
  s_sub_u32 s60, s63, s60
  s_lshl_b32 s60, s60, 6
  s_add_u32 s60, s60, s20
  s_add_u32 s60, s60, 524288
  v_add_u32 v228, s60, v10
  v_and_b32 v11, 1, v3
  v_lshlrev_b32 v10, 4, v11
  v_mov_b32 v9, 0x3f80
  v_lshlrev_b32 v10, v10, v9
  v_lshrrev_b32 v9, 1, v3
  v_cmp_eq_u32 vcc, 0, v9
  s_nop 1
  v_cndmask_b32 v224, 0, v10, vcc
  v_cmp_eq_u32 vcc, 1, v9
  s_nop 1
  v_cndmask_b32 v225, 0, v10, vcc
  v_cmp_eq_u32 vcc, 2, v9
  s_nop 1
  v_cndmask_b32 v226, 0, v10, vcc
  v_cmp_eq_u32 vcc, 3, v9
  s_nop 1
  v_cndmask_b32 v227, 0, v10, vcc
  v_bfe_u32 v10, v3, 1, 1
  v_lshlrev_b32 v10, 4, v10
  v_and_b32 v9, 1, v4
  v_lshl_or_b32 v10, v9, 3, v10
  s_lshl_b32 s60, s63, 5
  v_add_u32 v10, s60, v10
  v_mul_u32_u24 v9, 1280, v11
  v_add_u32 v229, v10, v9
  v_and_b32 v9, 7, v2
  s_lshl_b32 s60, s52, 10
  s_add_u32 s60, s60, 32768
  s_add_u32 s60, s60, s20
  v_lshl_add_u32 v230, v9, 7, s60
  s_mov_b32 s5, 65536
  s_mov_b32 s6, 131072
  s_mov_b32 s7, 196608
  s_mov_b32 s8, 262144
  s_mov_b32 s9, 327680
  s_mov_b32 s10, 393216
  v_mov_b32 v220, 0
  v_mov_b32 v221, 0
  v_mov_b32 v222, 0
  v_mov_b32 v223, 0
  v_not_b32 v13, s55
  s_mov_b64 vcc, 0xff
  s_mov_b32 s64, 200000
L_poll5:
  s_mov_b64 exec, vcc
  buffer_load_dword v13, v230, s[28:31], 0 offen sc1
  s_sub_u32 s64, s64, 1
  s_cbranch_scc1 L_end
  s_waitcnt vmcnt(0)
  v_cmp_ne_u32 vcc, s55, v13
  s_cbranch_vccnz L_poll5
  s_mov_b64 exec, -1
  s_mov_b32 s64, 200000
L_poll6:
  s_mov_b32 exec_hi, 0xfffff
  buffer_load_dwordx4 v[220:223], v228, s[28:31], s10 offen sc1
  s_mov_b32 exec_hi, -1
  buffer_load_dwordx4 v[196:199], v228, s[28:31], 0 offen sc1
  buffer_load_dwordx4 v[200:203], v228, s[28:31], s5 offen sc1
  buffer_load_dwordx4 v[204:207], v228, s[28:31], s6 offen sc1
  buffer_load_dwordx4 v[208:211], v228, s[28:31], s7 offen sc1
  buffer_load_dwordx4 v[212:215], v228, s[28:31], s8 offen sc1
  buffer_load_dwordx4 v[216:219], v228, s[28:31], s9 offen sc1
  s_sub_u32 s64, s64, 1
  s_cbranch_scc1 L_end
  v_mov_b32 v112, 0
  s_mov_b32 exec_hi, 0xfffff
  s_waitcnt vmcnt(6)
  v_xor_b32 v220, s56, v220
  v_xor_b32 v221, s57, v221
  v_xor_b32 v222, s58, v222
  v_xor_b32 v223, s59, v223
  v_or3_b32 v112, v220, v221, v112
  v_or3_b32 v112, v222, v223, v112
  s_mov_b32 exec_hi, -1
  v_mfma_f32_16x16x32_bf16 v[116:119], v[224:227], v[220:223], 0
  s_waitcnt vmcnt(5)
  v_xor_b32 v196, s56, v196
  v_xor_b32 v197, s57, v197
  v_xor_b32 v198, s58, v198
  v_xor_b32 v199, s59, v199
  v_or3_b32 v112, v196, v197, v112
  v_or3_b32 v112, v198, v199, v112
  v_mfma_f32_16x16x32_bf16 v[116:119], v[224:227], v[196:199], v[116:119]
  s_waitcnt vmcnt(4)
  v_xor_b32 v200, s56, v200
  v_xor_b32 v201, s57, v201
  v_xor_b32 v202, s58, v202
  v_xor_b32 v203, s59, v203
  v_or3_b32 v112, v200, v201, v112
  v_or3_b32 v112, v202, v203, v112
  v_mfma_f32_16x16x32_bf16 v[116:119], v[224:227], v[200:203], v[116:119]
  s_waitcnt vmcnt(3)
  v_xor_b32 v204, s56, v204
  v_xor_b32 v205, s57, v205
  v_xor_b32 v206, s58, v206
  v_xor_b32 v207, s59, v207
  v_or3_b32 v112, v204, v205, v112
  v_or3_b32 v112, v206, v207, v112
  v_mfma_f32_16x16x32_bf16 v[116:119], v[224:227], v[204:207], v[116:119]
  s_waitcnt vmcnt(2)
  v_xor_b32 v208, s56, v208
  v_xor_b32 v209, s57, v209
  v_xor_b32 v210, s58, v210
  v_xor_b32 v211, s59, v211
  v_or3_b32 v112, v208, v209, v112
  v_or3_b32 v112, v210, v211, v112
  v_mfma_f32_16x16x32_bf16 v[116:119], v[224:227], v[208:211], v[116:119]
  s_waitcnt vmcnt(1)
  v_xor_b32 v212, s56, v212
  v_xor_b32 v213, s57, v213
  v_xor_b32 v214, s58, v214
  v_xor_b32 v215, s59, v215
  v_or3_b32 v112, v212, v213, v112
  v_or3_b32 v112, v214, v215, v112
L_hop_WB_4:
  s_cbranch_execz L_hop_WB_ret
  v_mfma_f32_16x16x32_bf16 v[116:119], v[224:227], v[212:215], v[116:119]
  s_waitcnt vmcnt(0)
  v_xor_b32 v216, s56, v216
  v_xor_b32 v217, s57, v217
  v_xor_b32 v218, s58, v218
  v_xor_b32 v219, s59, v219
  v_or3_b32 v112, v216, v217, v112
  v_or3_b32 v112, v218, v219, v112
  v_mfma_f32_16x16x32_bf16 v[116:119], v[224:227], v[216:219], v[116:119]
  v_and_b32 v112, 0x10001, v112
  v_cmp_ne_u32 vcc, 0, v112
  s_cbranch_vccnz L_poll6
  s_nop 4
  v_add_f32_dpp v116, v116, v116 row_ror:8 row_mask:0xf bank_mask:0xf
  v_add_f32_dpp v117, v117, v117 row_ror:8 row_mask:0xf bank_mask:0xf
  v_add_f32_dpp v118, v118, v118 row_ror:8 row_mask:0xf bank_mask:0xf
  v_add_f32_dpp v119, v119, v119 row_ror:8 row_mask:0xf bank_mask:0xf
  v_add_f32_dpp v116, v116, v116 row_ror:4 row_mask:0xf bank_mask:0xf
  v_add_f32_dpp v117, v117, v117 row_ror:4 row_mask:0xf bank_mask:0xf
  v_add_f32_dpp v118, v118, v118 row_ror:4 row_mask:0xf bank_mask:0xf
  v_add_f32_dpp v119, v119, v119 row_ror:4 row_mask:0xf bank_mask:0xf
  s_mov_b64 exec, 0xf000f
  v_cvt_pk_bf16_f32 v116, v116, v117
  v_cvt_pk_bf16_f32 v117, v118, v119
  buffer_store_dwordx2 v[116:117], v229, s[44:47], 0 offen
  s_cmp_lg_u32 s63, 0
  s_cbranch_scc1 L_w_done
  s_mov_b64 exec, 1
  buffer_store_dword v40, off, s[28:31], 0 sc1
L_w_done:
  s_endpgm
L_roleA:
  s_mov_b32 s38, 2211840
  s_mov_b32 s39, 0x20000
  s_mov_b64 s[36:37], s[18:19]
  s_mov_b32 s42, 2211840
  s_mov_b32 s43, 0x20000
  s_mov_b64 s[40:41], s[20:21]
  s_mov_b32 s46, 2560
  s_mov_b32 s47, 0x20000
  s_mov_b64 s[44:45], s[22:23]
  s_mov_b32 s50, 5242880
  s_mov_b32 s51, 0x20000
  s_mov_b64 s[48:49], s[14:15]
  s_and_b32 s61, s53, 15
  s_lshl_b32 s61, s61, 2
  s_add_u32 s61, s61, s54
  s_mul_i32 s61, s61, 7040
  s_mul_i32 s62, s52, 655360
  s_add_u32 s61, s61, s62
  s_add_u32 s61, s61, 204800
  v_lshl_add_u32 v14, v2, 7, s61
  v_and_b32 v10, 7, v3
  v_lshrrev_b32 v11, 3, v3
  v_lshl_or_b32 v10, v10, 1, v11
  v_lshlrev_b32 v11, 2, v4
  v_xor_b32 v10, v10, v11
  v_lshlrev_b32 v10, 4, v10
  v_lshl_or_b32 v10, v3, 8, v10
  v_xor_b32 v11, 0, v10
  v_add_u32 v16, s71, v11
  v_add_u32 v20, 0x10000, v16
  v_add_u32 v24, 131072, v11
  v_xor_b32 v11, 16, v10
  v_add_u32 v17, s71, v11
  v_add_u32 v21, 0x10000, v17
  v_add_u32 v25, 131072, v11
  v_xor_b32 v11, 32, v10
  v_add_u32 v18, s71, v11
  v_add_u32 v22, 0x10000, v18
  v_add_u32 v26, 131072, v11
  v_xor_b32 v11, 48, v10
  v_add_u32 v19, s71, v11
  v_add_u32 v23, 0x10000, v19
  v_add_u32 v27, 131072, v11
  v_lshrrev_b32 v10, 2, v2
  v_and_b32 v11, 7, v10
  v_lshrrev_b32 v12, 3, v10
  v_lshl_or_b32 v11, v11, 1, v12
  v_bfe_u32 v12, v3, 1, 1
  s_lshl_b32 s61, s54, 2
  v_or_b32 v12, s61, v12
  v_xor_b32 v11, v11, v12
  v_lshlrev_b32 v11, 4, v11
  v_lshl_or_b32 v10, v10, 8, v11
  v_and_b32 v12, 1, v3
  v_lshl_or_b32 v28, v12, 3, v10
  v_xor_b32 v29, 32, v28
  v_add_u32 v30, 0x10000, v28
  v_add_u32 v31, 0x10000, v29
  s_and_b32 s61, s54, 1
  s_lshl_b32 s61, s61, 3
  s_lshr_b32 s62, s54, 1
  s_or_b32 s61, s61, s62
  v_xor_b32 v10, s61, v3
  v_lshlrev_b32 v10, 4, v10
  v_lshl_or_b32 v10, v4, 12, v10
  s_lshl_b32 s61, s54, 10
  s_add_u32 s61, s61, 131072
  v_add_u32 v32, s61, v10
  v_xor_b32 v33, 288, v32
  v_xor_b32 v34, 576, v32
  v_xor_b32 v35, 864, v32
  v_lshlrev_b32 v37, 4, v2
  s_lshr_b32 s19, s52, 2
  s_lshl_b32 s19, s19, 13
  s_mul_i32 s62, s19, 9
  s_lshl_b32 s61, s70, 15
  s_add_u32 s61, s61, s62
  s_and_b32 s62, s54, 2
  s_add_u32 s62, s62, s54
  s_lshl_b32 s62, s62, 12
  s_add_u32 s61, s61, s62
  s_add_u32 s61, s61, 1310720
  v_add_u32 v36, s61, v37
  s_lshr_b32 s6, s69, 1
  s_lshl_b32 s6, s6, 15
  s_add_u32 s6, s6, s62
  s_lshl_b32 s62, s70, 13
  s_add_u32 s6, s6, s62
  s_xor_b32 s6, s6, 2105344
  s_lshl_b32 s4, s52, 5
  s_add_u32 s4, s4, s53
  s_lshl_b32 s4, s4, 2
  s_add_u32 s4, s4, 4032
  s_lshr_b32 s5, s69, 1
  s_and_b32 s61, s5, 48
  s_add_u32 s5, s5, s61
  s_lshl_b32 s5, s5, 9
  s_add_u32 s5, s5, s62
  s_add_u32 s5, s5, 262144
  v_lshrrev_b32 v10, 2, v3
  v_and_b32 v11, 3, v3
  v_lshlrev_b32 v11, 4, v11
  v_lshl_or_b32 v42, v10, 7, v11
  v_lshl_or_b32 v42, v4, 6, v42
  v_add_u32 v40, 147456, v37
  s_lshl_b32 s61, s54, 10
  v_add_u32 v38, s61, v40
  s_lshl_b32 s61, s54, 2
  s_add_u32 s61, s61, 4096
  v_add_u32 v39, s61, v40
  v_lshlrev_b32 v41, 2, v3
  v_add_u32 v41, 152576, v41
  v_bfrev_b32 v10, 1
  ds_write_b32 v41, v10
  v_mov_b32 v44, 0x3f803f80
  v_mov_b32 v45, 0x3f803f80
  v_mov_b32 v46, 0x3f803f80
  v_mov_b32 v47, 0x3f803f80
  s_bfe_u32 s61, s53, 0x20002
  s_lshl_b32 s61, s61, 3
  s_add_u32 s61, s61, s52
  s_lshl_b32 s72, s61, 2
  s_and_b32 s61, s53, 3
  s_add_u32 s72, s72, s61
  s_add_u32 s60, s16, 0
  s_add_u32 m0, s71, 0
  s_nop 0
  buffer_load_dwordx4 v6, s[32:35], s60 offen lds
  s_add_u32 m0, s71, 1024
  s_nop 0
  buffer_load_dwordx4 v7, s[32:35], s60 offen lds
  s_add_u32 m0, s71, 2048
  s_nop 0
  buffer_load_dwordx4 v8, s[32:35], s60 offen lds
  s_add_u32 m0, s71, 3072
  s_nop 0
  buffer_load_dwordx4 v9, s[32:35], s60 offen lds
  s_waitcnt lgkmcnt(0)
  s_add_u32 s55, s55, 1
  v_and_b32 v50, 3, v2
  v_lshlrev_b32 v50, 1, v50
  v_lshrrev_b32 v50, v50, s55
  v_and_b32 v48, 1, v50
  v_and_b32 v50, 2, v50
  v_lshl_or_b32 v48, v50, 15, v48
  v_mov_b32 v49, 0xfffefffe
  v_mov_b32 v50, s55
  v_readlane_b32 s56, v48, 0
  v_readlane_b32 s57, v48, 1
  v_readlane_b32 s58, v48, 2
  v_readlane_b32 s59, v48, 3
  s_cmp_lg_u32 s54, 3
  s_cbranch_scc1 L_nowarmAA
  s_mov_b64 exec, 0
  s_branch L_hop_AA_0
L_hop_AA_ret:
  s_mov_b64 exec, -1
L_nowarmAA:
L_hop_AA_0:
  s_cbranch_execz L_hop_AA_1
  s_add_u32 s60, s16, 256
  s_add_u32 m0, s71, 32768
  s_nop 0
  buffer_load_dwordx4 v6, s[32:35], s60 offen lds
  s_add_u32 m0, s71, 33792
  s_nop 0
  buffer_load_dwordx4 v7, s[32:35], s60 offen lds
  s_add_u32 m0, s71, 34816
  s_nop 0
  buffer_load_dwordx4 v8, s[32:35], s60 offen lds
  s_add_u32 m0, s71, 35840
  s_nop 0
  buffer_load_dwordx4 v9, s[32:35], s60 offen lds
  s_add_u32 s60, s16, 512
  s_add_u32 m0, s71, 65536
  s_nop 0
  buffer_load_dwordx4 v6, s[32:35], s60 offen lds
  s_add_u32 m0, s71, 66560
  s_nop 0
  buffer_load_dwordx4 v7, s[32:35], s60 offen lds
  s_add_u32 m0, s71, 67584
  s_nop 0
  buffer_load_dwordx4 v8, s[32:35], s60 offen lds
  s_add_u32 m0, s71, 68608
  s_nop 0
  buffer_load_dwordx4 v9, s[32:35], s60 offen lds
  s_waitcnt vmcnt(8)
  s_add_u32 s60, s16, 768
  s_add_u32 m0, s71, 98304
  s_nop 0
  buffer_load_dwordx4 v6, s[32:35], s60 offen lds
  s_add_u32 m0, s71, 99328
  s_nop 0
  buffer_load_dwordx4 v7, s[32:35], s60 offen lds
  s_add_u32 m0, s71, 100352
  s_nop 0
  buffer_load_dwordx4 v8, s[32:35], s60 offen lds
  s_add_u32 m0, s71, 101376
  s_nop 0
  buffer_load_dwordx4 v9, s[32:35], s60 offen lds
  s_barrier
  ds_read_b128 a[0:3], v16 offset:0
  ds_read_b128 a[4:7], v17 offset:0
  ds_read_b128 a[8:11], v18 offset:0
  ds_read_b128 a[12:15], v19 offset:0
  ds_read_b64_tr_b16 a[128:129], v28 offset:0
  ds_read_b64_tr_b16 a[132:133], v29 offset:0
  ds_read_b64_tr_b16 a[160:161], v28 offset:8192
  ds_read_b64_tr_b16 a[164:165], v29 offset:8192
  ds_read_b64_tr_b16 a[192:193], v28 offset:16384
  ds_read_b64_tr_b16 a[196:197], v29 offset:16384
  ds_read_b64_tr_b16 a[224:225], v28 offset:24576
  ds_read_b64_tr_b16 a[228:229], v29 offset:24576
  s_waitcnt vmcnt(8)
  s_add_u32 s60, s17, 0
  s_add_u32 m0, s71, 4096
  s_nop 0
  buffer_load_dwordx4 v6, s[32:35], s60 offen lds
  s_add_u32 m0, s71, 5120
  s_nop 0
  buffer_load_dwordx4 v7, s[32:35], s60 offen lds
  s_add_u32 m0, s71, 6144
  s_nop 0
  buffer_load_dwordx4 v8, s[32:35], s60 offen lds
  s_add_u32 m0, s71, 7168
  s_nop 0
  buffer_load_dwordx4 v9, s[32:35], s60 offen lds
  s_barrier
  ds_read_b128 a[16:19], v16 offset:32768
  ds_read_b128 a[20:23], v17 offset:32768
  ds_read_b128 a[24:27], v18 offset:32768
  ds_read_b128 a[28:31], v19 offset:32768
  ds_read_b64_tr_b16 a[136:137], v28 offset:32768
  ds_read_b64_tr_b16 a[140:141], v29 offset:32768
  ds_read_b64_tr_b16 a[168:169], v28 offset:40960
  ds_read_b64_tr_b16 a[172:173], v29 offset:40960
  ds_read_b64_tr_b16 a[200:201], v28 offset:49152
  ds_read_b64_tr_b16 a[204:205], v29 offset:49152
  ds_read_b64_tr_b16 a[232:233], v28 offset:57344
  ds_read_b64_tr_b16 a[236:237], v29 offset:57344
  s_waitcnt vmcnt(8)
  s_add_u32 s60, s17, 256
  s_add_u32 m0, s71, 36864
  s_nop 0
  buffer_load_dwordx4 v6, s[32:35], s60 offen lds
  s_add_u32 m0, s71, 37888
L_hop_AA_1:
  s_cbranch_execz L_hop_AA_2
  buffer_load_dwordx4 v7, s[32:35], s60 offen lds
  s_add_u32 m0, s71, 38912
  s_nop 0
  buffer_load_dwordx4 v8, s[32:35], s60 offen lds
  s_add_u32 m0, s71, 39936
  s_nop 0
  buffer_load_dwordx4 v9, s[32:35], s60 offen lds
  s_barrier
  ds_read_b128 a[32:35], v20 offset:0
  ds_read_b128 a[36:39], v21 offset:0
  ds_read_b128 a[40:43], v22 offset:0
  ds_read_b128 a[44:47], v23 offset:0
  ds_read_b64_tr_b16 a[144:145], v30 offset:0
  ds_read_b64_tr_b16 a[148:149], v31 offset:0
  ds_read_b64_tr_b16 a[176:177], v30 offset:8192
  ds_read_b64_tr_b16 a[180:181], v31 offset:8192
  ds_read_b64_tr_b16 a[208:209], v30 offset:16384
  ds_read_b64_tr_b16 a[212:213], v31 offset:16384
  ds_read_b64_tr_b16 a[240:241], v30 offset:24576
  ds_read_b64_tr_b16 a[244:245], v31 offset:24576
  s_waitcnt vmcnt(8)
  s_add_u32 s60, s17, 512
  s_add_u32 m0, s71, 69632
  s_nop 0
  buffer_load_dwordx4 v6, s[32:35], s60 offen lds
  s_add_u32 m0, s71, 70656
  s_nop 0
  buffer_load_dwordx4 v7, s[32:35], s60 offen lds
  s_add_u32 m0, s71, 71680
  s_nop 0
  buffer_load_dwordx4 v8, s[32:35], s60 offen lds
  s_add_u32 m0, s71, 72704
  s_nop 0
  buffer_load_dwordx4 v9, s[32:35], s60 offen lds
  s_load_dword s3, s[24:25], 0
  s_barrier
  ds_read_b128 a[48:51], v20 offset:32768
  ds_read_b128 a[52:55], v21 offset:32768
  ds_read_b128 a[56:59], v22 offset:32768
  ds_read_b128 a[60:63], v23 offset:32768
  ds_read_b64_tr_b16 a[152:153], v30 offset:32768
  ds_read_b64_tr_b16 a[156:157], v31 offset:32768
  ds_read_b64_tr_b16 a[184:185], v30 offset:40960
  ds_read_b64_tr_b16 a[188:189], v31 offset:40960
  ds_read_b64_tr_b16 a[216:217], v30 offset:49152
  ds_read_b64_tr_b16 a[220:221], v31 offset:49152
  ds_read_b64_tr_b16 a[248:249], v30 offset:57344
  ds_read_b64_tr_b16 a[252:253], v31 offset:57344
  s_waitcnt vmcnt(8)
  s_add_u32 s60, s17, 768
  s_add_u32 m0, s71, 102400
  s_nop 0
  buffer_load_dwordx4 v6, s[32:35], s60 offen lds
  s_add_u32 m0, s71, 103424
  s_nop 0
  buffer_load_dwordx4 v7, s[32:35], s60 offen lds
  s_add_u32 m0, s71, 104448
  s_nop 0
  buffer_load_dwordx4 v8, s[32:35], s60 offen lds
  s_add_u32 m0, s71, 105472
  s_nop 0
  buffer_load_dwordx4 v9, s[32:35], s60 offen lds
  s_barrier
  ds_read_b128 a[64:67], v16 offset:4096
  ds_read_b128 a[68:71], v17 offset:4096
  ds_read_b128 a[72:75], v18 offset:4096
  ds_read_b128 a[76:79], v19 offset:4096
  ds_read_b64_tr_b16 a[130:131], v28 offset:4096
  ds_read_b64_tr_b16 a[134:135], v29 offset:4096
  ds_read_b64_tr_b16 a[162:163], v28 offset:12288
  ds_read_b64_tr_b16 a[166:167], v29 offset:12288
  ds_read_b64_tr_b16 a[194:195], v28 offset:20480
  ds_read_b64_tr_b16 a[198:199], v29 offset:20480
  ds_read_b64_tr_b16 a[226:227], v28 offset:28672
  ds_read_b64_tr_b16 a[230:231], v29 offset:28672
  s_waitcnt vmcnt(8)
  s_mov_b32 s64, 200000
  s_waitcnt lgkmcnt(0)
  s_cmp_lg_u32 s3, 0
  s_cbranch_scc1 L_a_P_ok
L_a_P:
  s_load_dword s3, s[24:25], 0 glc
  s_sub_u32 s64, s64, 1
  s_cbranch_scc1 L_end
  s_waitcnt lgkmcnt(0)
  s_cmp_eq_u32 s3, 0
  s_cbranch_scc1 L_a_P
L_a_P_ok:
  s_and_b32 s3, s3, 2
  s_lshl_b32 s3, s3, 12
  v_xor_b32 v36, s3, v36
  s_xor_b32 s6, s6, s3
  s_xor_b32 s5, s5, s3
  s_xor_b32 s19, s19, s3
  buffer_load_dwordx4 v[52:55], v36, s[28:31], 0 offen offset:0 sc1
  buffer_load_dwordx4 v[56:59], v36, s[28:31], 0 offen offset:1024 sc1
  buffer_load_dwordx4 v[60:63], v36, s[28:31], 0 offen offset:2048 sc1
  buffer_load_dwordx4 v[64:67], v36, s[28:31], 0 offen offset:3072 sc1
  s_barrier
  ds_read_b128 a[80:83], v16 offset:36864
  ds_read_b128 a[84:87], v17 offset:36864
  ds_read_b128 a[88:91], v18 offset:36864
  ds_read_b128 a[92:95], v19 offset:36864
  ds_read_b64_tr_b16 a[138:139], v28 offset:36864
  ds_read_b64_tr_b16 a[142:143], v29 offset:36864
  ds_read_b64_tr_b16 a[170:171], v28 offset:45056
  ds_read_b64_tr_b16 a[174:175], v29 offset:45056
  ds_read_b64_tr_b16 a[202:203], v28 offset:53248
  ds_read_b64_tr_b16 a[206:207], v29 offset:53248
  ds_read_b64_tr_b16 a[234:235], v28 offset:61440
  ds_read_b64_tr_b16 a[238:239], v29 offset:61440
  s_waitcnt vmcnt(8)
  s_barrier
  ds_read_b128 a[96:99], v20 offset:4096
  ds_read_b128 a[100:103], v21 offset:4096
  ds_read_b128 a[104:107], v22 offset:4096
  ds_read_b128 a[108:111], v23 offset:4096
  ds_read_b64_tr_b16 a[146:147], v30 offset:4096
  ds_read_b64_tr_b16 a[150:151], v31 offset:4096
  ds_read_b64_tr_b16 a[178:179], v30 offset:12288
  ds_read_b64_tr_b16 a[182:183], v31 offset:12288
  ds_read_b64_tr_b16 a[210:211], v30 offset:20480
  ds_read_b64_tr_b16 a[214:215], v31 offset:20480
  ds_read_b64_tr_b16 a[242:243], v30 offset:28672
  ds_read_b64_tr_b16 a[246:247], v31 offset:28672
  s_waitcnt vmcnt(4)
  s_barrier
  ds_read_b128 a[112:115], v20 offset:36864
  ds_read_b128 a[116:119], v21 offset:36864
  ds_read_b128 a[120:123], v22 offset:36864
  ds_read_b128 a[124:127], v23 offset:36864
L_hop_AA_2:
  s_cbranch_execz L_hop_AA_3
  ds_read_b64_tr_b16 a[154:155], v30 offset:36864
  ds_read_b64_tr_b16 a[158:159], v31 offset:36864
  ds_read_b64_tr_b16 a[186:187], v30 offset:45056
  ds_read_b64_tr_b16 a[190:191], v31 offset:45056
  ds_read_b64_tr_b16 a[218:219], v30 offset:53248
  ds_read_b64_tr_b16 a[222:223], v31 offset:53248
  ds_read_b64_tr_b16 a[250:251], v30 offset:61440
  ds_read_b64_tr_b16 a[254:255], v31 offset:61440
  s_mov_b32 s64, 200000
  s_waitcnt vmcnt(3)
  v_xor_b32 v52, s56, v52
  v_xor_b32 v53, s57, v53
  v_xor_b32 v54, s58, v54
  v_xor_b32 v55, s59, v55
  v_or3_b32 v80, v52, v53, v54
  v_or_b32 v80, v80, v55
  ds_write_b128 v32, v[52:55]
  s_waitcnt vmcnt(2)
  v_xor_b32 v56, s56, v56
  v_xor_b32 v57, s57, v57
  v_xor_b32 v58, s58, v58
  v_xor_b32 v59, s59, v59
  v_or3_b32 v80, v56, v57, v80
  v_or3_b32 v80, v58, v59, v80
  ds_write_b128 v33, v[56:59]
  s_waitcnt vmcnt(1)
  v_xor_b32 v60, s56, v60
  v_xor_b32 v61, s57, v61
  v_xor_b32 v62, s58, v62
  v_xor_b32 v63, s59, v63
  v_or3_b32 v80, v60, v61, v80
  v_or3_b32 v80, v62, v63, v80
  ds_write_b128 v34, v[60:63]
  s_waitcnt vmcnt(0)
  v_xor_b32 v64, s56, v64
  v_xor_b32 v65, s57, v65
  v_xor_b32 v66, s58, v66
  v_xor_b32 v67, s59, v67
  v_or3_b32 v80, v64, v65, v80
  v_or3_b32 v80, v66, v67, v80
  ds_write_b128 v35, v[64:67]
  v_and_b32 v80, 0x10001, v80
  v_cmp_ne_u32 vcc, 0, v80
  s_cbranch_vccz L_a_e1ok
L_a_e1retry:
  buffer_load_dwordx4 v[52:55], v36, s[28:31], 0 offen offset:0 sc1
  buffer_load_dwordx4 v[56:59], v36, s[28:31], 0 offen offset:1024 sc1
  buffer_load_dwordx4 v[60:63], v36, s[28:31], 0 offen offset:2048 sc1
  buffer_load_dwordx4 v[64:67], v36, s[28:31], 0 offen offset:3072 sc1
  s_sub_u32 s64, s64, 1
  s_cbranch_scc1 L_end
  s_waitcnt vmcnt(3)
  v_xor_b32 v52, s56, v52
  v_xor_b32 v53, s57, v53
  v_xor_b32 v54, s58, v54
  v_xor_b32 v55, s59, v55
  v_or3_b32 v80, v52, v53, v54
  v_or_b32 v80, v80, v55
  ds_write_b128 v32, v[52:55]
  s_waitcnt vmcnt(2)
  v_xor_b32 v56, s56, v56
  v_xor_b32 v57, s57, v57
  v_xor_b32 v58, s58, v58
  v_xor_b32 v59, s59, v59
  v_or3_b32 v80, v56, v57, v80
  v_or3_b32 v80, v58, v59, v80
  ds_write_b128 v33, v[56:59]
  s_waitcnt vmcnt(1)
  v_xor_b32 v60, s56, v60
  v_xor_b32 v61, s57, v61
  v_xor_b32 v62, s58, v62
  v_xor_b32 v63, s59, v63
  v_or3_b32 v80, v60, v61, v80
  v_or3_b32 v80, v62, v63, v80
  ds_write_b128 v34, v[60:63]
  s_waitcnt vmcnt(0)
  v_xor_b32 v64, s56, v64
  v_xor_b32 v65, s57, v65
  v_xor_b32 v66, s58, v66
  v_xor_b32 v67, s59, v67
  v_or3_b32 v80, v64, v65, v80
  v_or3_b32 v80, v66, v67, v80
  ds_write_b128 v35, v[64:67]
  v_and_b32 v80, 0x10001, v80
  v_cmp_ne_u32 vcc, 0, v80
  s_cbranch_vccnz L_a_e1retry
L_a_e1ok:
  s_waitcnt lgkmcnt(0)
  s_barrier
  ds_read_b128 v[84:87], v24 offset:0
  s_cmp_lg_u32 s54, 0
  s_cbranch_scc1 L_a_fa
  s_mov_b64 exec, 1
  buffer_store_dword v50, off, s[28:31], s4
  s_mov_b64 exec, -1
L_a_fa:
  ds_read_b128 v[88:91], v25 offset:0
  ds_read_b128 v[92:95], v26 offset:0
  s_bfm_b64 exec, 55, 0
  buffer_load_dword v13, v14, s[48:51], 0 offen
  s_mov_b64 exec, -1
  ds_read_b128 v[96:99], v27 offset:0
  ds_read_b128 v[100:103], v24 offset:4096
  ds_read_b128 v[104:107], v25 offset:4096
  ds_read_b128 v[108:111], v26 offset:4096
  ds_read_b128 v[112:115], v27 offset:4096
  ds_read_b128 v[116:119], v24 offset:8192
  s_waitcnt lgkmcnt(7)
  v_mfma_f32_16x16x32_bf16 v[148:151], a[0:3], v[84:87], 0
  v_mfma_f32_16x16x32_bf16 v[152:155], a[64:67], v[84:87], 0
  ds_read_b128 v[120:123], v25 offset:8192
  v_mfma_f32_16x16x32_bf16 v[148:151], a[4:7], v[88:91], v[148:151]
  v_mfma_f32_16x16x32_bf16 v[152:155], a[68:71], v[88:91], v[152:155]
  ds_read_b128 v[124:127], v26 offset:8192
  s_waitcnt lgkmcnt(7)
  v_mfma_f32_16x16x32_bf16 v[148:151], a[8:11], v[92:95], v[148:151]
  v_mfma_f32_16x16x32_bf16 v[152:155], a[72:75], v[92:95], v[152:155]
  ds_read_b128 v[128:131], v27 offset:8192
  v_mfma_f32_16x16x32_bf16 v[148:151], a[12:15], v[96:99], v[148:151]
  v_mfma_f32_16x16x32_bf16 v[152:155], a[76:79], v[96:99], v[152:155]
  ds_read_b128 v[132:135], v24 offset:12288
  s_waitcnt lgkmcnt(7)
  v_mfma_f32_16x16x32_bf16 v[148:151], a[16:19], v[100:103], v[148:151]
  v_mfma_f32_16x16x32_bf16 v[152:155], a[80:83], v[100:103], v[152:155]
  ds_read_b128 v[136:139], v25 offset:12288
  v_mfma_f32_16x16x32_bf16 v[148:151], a[20:23], v[104:107], v[148:151]
  v_mfma_f32_16x16x32_bf16 v[152:155], a[84:87], v[104:107], v[152:155]
  ds_read_b128 v[140:143], v26 offset:12288
  s_waitcnt lgkmcnt(7)
  v_mfma_f32_16x16x32_bf16 v[148:151], a[24:27], v[108:111], v[148:151]
  v_mfma_f32_16x16x32_bf16 v[152:155], a[88:91], v[108:111], v[152:155]
  ds_read_b128 v[144:147], v27 offset:12288
  v_mfma_f32_16x16x32_bf16 v[148:151], a[28:31], v[112:115], v[148:151]
  v_mfma_f32_16x16x32_bf16 v[152:155], a[92:95], v[112:115], v[152:155]
  s_waitcnt lgkmcnt(6)
  v_mfma_f32_16x16x32_bf16 v[148:151], a[32:35], v[116:119], v[148:151]
  v_mfma_f32_16x16x32_bf16 v[152:155], a[96:99], v[116:119], v[152:155]
  v_mfma_f32_16x16x32_bf16 v[148:151], a[36:39], v[120:123], v[148:151]
  v_mfma_f32_16x16x32_bf16 v[152:155], a[100:103], v[120:123], v[152:155]
  s_waitcnt lgkmcnt(4)
  v_mfma_f32_16x16x32_bf16 v[148:151], a[40:43], v[124:127], v[148:151]
  v_mfma_f32_16x16x32_bf16 v[152:155], a[104:107], v[124:127], v[152:155]
  v_mfma_f32_16x16x32_bf16 v[148:151], a[44:47], v[128:131], v[148:151]
  v_mfma_f32_16x16x32_bf16 v[152:155], a[108:111], v[128:131], v[152:155]
  s_waitcnt lgkmcnt(2)
  v_mfma_f32_16x16x32_bf16 v[148:151], a[48:51], v[132:135], v[148:151]
L_hop_AA_3:
  s_cbranch_execz L_hop_AA_4
  v_mfma_f32_16x16x32_bf16 v[152:155], a[112:115], v[132:135], v[152:155]
  v_mfma_f32_16x16x32_bf16 v[148:151], a[52:55], v[136:139], v[148:151]
  v_mfma_f32_16x16x32_bf16 v[152:155], a[116:119], v[136:139], v[152:155]
  s_waitcnt lgkmcnt(0)
  v_mfma_f32_16x16x32_bf16 v[148:151], a[56:59], v[140:143], v[148:151]
  v_mfma_f32_16x16x32_bf16 v[152:155], a[120:123], v[140:143], v[152:155]
  v_mfma_f32_16x16x32_bf16 v[148:151], a[60:63], v[144:147], v[148:151]
  v_mfma_f32_16x16x32_bf16 v[152:155], a[124:127], v[144:147], v[152:155]
  s_nop 6
  v_max3_f32 v156, v148, v149, v150
  v_max3_f32 v156, v156, v151, v152
  v_max3_f32 v10, v153, v154, v155
  v_max_f32 v156, v156, v10
  v_ceil_f32 v156, v156
  v_sub_f32 v148, v148, v156
  v_cvt_i32_f32 v157, v156
  v_sub_f32 v149, v149, v156
  v_sub_f32 v150, v150, v156
  v_sub_f32 v151, v151, v156
  v_sub_f32 v152, v152, v156
  v_sub_f32 v153, v153, v156
  v_sub_f32 v154, v154, v156
  v_sub_f32 v155, v155, v156
  ds_max_i32 v41, v157
  ds_write_b32 v39, v157
  v_exp_f32 v148, v148
  v_exp_f32 v149, v149
  v_exp_f32 v150, v150
  v_exp_f32 v151, v151
  v_exp_f32 v152, v152
  v_exp_f32 v153, v153
  v_exp_f32 v154, v154
  v_exp_f32 v155, v155
  v_cvt_pk_bf16_f32 v160, v148, v149
  v_cvt_pk_bf16_f32 v161, v150, v151
  v_cvt_pk_bf16_f32 v162, v152, v153
  v_cvt_pk_bf16_f32 v163, v154, v155
  ds_write_b128 v38, v[160:163]
  s_waitcnt lgkmcnt(0)
  s_barrier
  ds_read_b32 v220, v41
  ds_read_b128 v[180:183], v40 offset:4096
  ds_read_b128 v[164:167], v40 offset:0
  ds_read_b128 v[168:171], v40 offset:1024
  ds_read_b128 v[172:175], v40 offset:2048
  ds_read_b128 v[176:179], v40 offset:3072
  s_waitcnt lgkmcnt(4)
  v_sub_u32 v180, v220, v180
  v_min_u32 v180, 0xff, v180
  v_mul_u32_u24 v180, 0x800080, v180
  s_waitcnt lgkmcnt(0)
  v_pk_sub_u16 v164, v164, v180 clamp
  v_pk_sub_u16 v165, v165, v180 clamp
  v_pk_sub_u16 v166, v166, v180 clamp
  v_pk_sub_u16 v167, v167, v180 clamp
  v_sub_u32 v181, v220, v181
  v_min_u32 v181, 0xff, v181
  v_mfma_f32_16x16x32_bf16 v[216:219], v[44:47], v[164:167], 0
  v_mul_u32_u24 v181, 0x800080, v181
  v_pk_sub_u16 v168, v168, v181 clamp
  v_mfma_f32_16x16x32_bf16 v[184:187], v[164:167], a[128:131], 0
  v_pk_sub_u16 v169, v169, v181 clamp
  v_pk_sub_u16 v170, v170, v181 clamp
  v_mfma_f32_16x16x32_bf16 v[188:191], v[164:167], a[132:135], 0
  v_pk_sub_u16 v171, v171, v181 clamp
  v_sub_u32 v182, v220, v182
  v_mfma_f32_16x16x32_bf16 v[192:195], v[164:167], a[136:139], 0
  v_min_u32 v182, 0xff, v182
  v_mul_u32_u24 v182, 0x800080, v182
  v_mfma_f32_16x16x32_bf16 v[216:219], v[44:47], v[168:171], v[216:219]
  v_pk_sub_u16 v172, v172, v182 clamp
  v_pk_sub_u16 v173, v173, v182 clamp
  v_mfma_f32_16x16x32_bf16 v[196:199], v[164:167], a[140:143], 0
  v_pk_sub_u16 v174, v174, v182 clamp
  v_pk_sub_u16 v175, v175, v182 clamp
  v_mfma_f32_16x16x32_bf16 v[200:203], v[164:167], a[144:147], 0
  v_sub_u32 v183, v220, v183
  v_min_u32 v183, 0xff, v183
  v_mfma_f32_16x16x32_bf16 v[216:219], v[44:47], v[172:175], v[216:219]
  v_mul_u32_u24 v183, 0x800080, v183
  v_pk_sub_u16 v176, v176, v183 clamp
  v_mfma_f32_16x16x32_bf16 v[204:207], v[164:167], a[148:151], 0
  v_pk_sub_u16 v177, v177, v183 clamp
  v_pk_sub_u16 v178, v178, v183 clamp
  v_mfma_f32_16x16x32_bf16 v[208:211], v[164:167], a[152:155], 0
  v_pk_sub_u16 v179, v179, v183 clamp
  s_nop 0
  v_mfma_f32_16x16x32_bf16 v[212:215], v[164:167], a[156:159], 0
  s_nop 1
  v_mfma_f32_16x16x32_bf16 v[216:219], v[44:47], v[176:179], v[216:219]
L_hop_AA_4:
  s_cbranch_execz L_hop_AA_5
  s_nop 0
  v_mfma_f32_16x16x32_bf16 v[184:187], v[168:171], a[160:163], v[184:187]
  s_nop 1
  v_mfma_f32_16x16x32_bf16 v[188:191], v[168:171], a[164:167], v[188:191]
  s_nop 1
  v_mfma_f32_16x16x32_bf16 v[184:187], v[172:175], a[192:195], v[184:187]
  v_mov_b32 v218, v220
  v_mov_b32 v216, s55
  v_mfma_f32_16x16x32_bf16 v[188:191], v[172:175], a[196:199], v[188:191]
  v_mov_b32 v219, s55
  s_cmp_lg_u32 s54, 0
  s_cbranch_scc1 L_a_st
  s_bfm_b64 exec, 32, 0
  buffer_store_dwordx4 v[216:219], v42, s[28:31], s5 offen sc1
  s_mov_b64 exec, -1
L_a_st:
  v_mfma_f32_16x16x32_bf16 v[184:187], v[176:179], a[224:227], v[184:187]
  s_nop 1
  v_mfma_f32_16x16x32_bf16 v[188:191], v[176:179], a[228:231], v[188:191]
  s_nop 1
  v_mfma_f32_16x16x32_bf16 v[192:195], v[168:171], a[168:171], v[192:195]
  s_nop 1
  v_mfma_f32_16x16x32_bf16 v[196:199], v[168:171], a[172:175], v[196:199]
  s_nop 1
  v_mfma_f32_16x16x32_bf16 v[192:195], v[172:175], a[200:203], v[192:195]
  v_cvt_pk_bf16_f32 v52, v184, v188
  v_cvt_pk_bf16_f32 v56, v185, v189
  v_mfma_f32_16x16x32_bf16 v[196:199], v[172:175], a[204:207], v[196:199]
  v_cvt_pk_bf16_f32 v60, v186, v190
  v_cvt_pk_bf16_f32 v64, v187, v191
  v_mfma_f32_16x16x32_bf16 v[192:195], v[176:179], a[232:235], v[192:195]
  v_and_or_b32 v52, v52, v49, s56
  v_and_or_b32 v56, v56, v49, s56
  v_mfma_f32_16x16x32_bf16 v[196:199], v[176:179], a[236:239], v[196:199]
  v_and_or_b32 v60, v60, v49, s56
  v_and_or_b32 v64, v64, v49, s56
  v_mfma_f32_16x16x32_bf16 v[200:203], v[168:171], a[176:179], v[200:203]
  s_nop 1
  v_mfma_f32_16x16x32_bf16 v[204:207], v[168:171], a[180:183], v[204:207]
  s_nop 1
  v_mfma_f32_16x16x32_bf16 v[200:203], v[172:175], a[208:211], v[200:203]
  v_cvt_pk_bf16_f32 v53, v192, v196
  v_cvt_pk_bf16_f32 v57, v193, v197
  v_mfma_f32_16x16x32_bf16 v[204:207], v[172:175], a[212:215], v[204:207]
  v_cvt_pk_bf16_f32 v61, v194, v198
  v_cvt_pk_bf16_f32 v65, v195, v199
  v_mfma_f32_16x16x32_bf16 v[200:203], v[176:179], a[240:243], v[200:203]
  v_and_or_b32 v53, v53, v49, s57
  v_and_or_b32 v57, v57, v49, s57
  v_mfma_f32_16x16x32_bf16 v[204:207], v[176:179], a[244:247], v[204:207]
  v_and_or_b32 v61, v61, v49, s57
L_hop_AA_5:
  s_cbranch_execz L_hop_AA_ret
  v_and_or_b32 v65, v65, v49, s57
  v_mfma_f32_16x16x32_bf16 v[208:211], v[168:171], a[184:187], v[208:211]
  s_nop 1
  v_mfma_f32_16x16x32_bf16 v[212:215], v[168:171], a[188:191], v[212:215]
  s_nop 1
  v_mfma_f32_16x16x32_bf16 v[208:211], v[172:175], a[216:219], v[208:211]
  v_cvt_pk_bf16_f32 v54, v200, v204
  v_cvt_pk_bf16_f32 v58, v201, v205
  v_mfma_f32_16x16x32_bf16 v[212:215], v[172:175], a[220:223], v[212:215]
  v_cvt_pk_bf16_f32 v62, v202, v206
  v_cvt_pk_bf16_f32 v66, v203, v207
  v_mfma_f32_16x16x32_bf16 v[208:211], v[176:179], a[248:251], v[208:211]
  v_and_or_b32 v54, v54, v49, s58
  v_and_or_b32 v58, v58, v49, s58
  v_mfma_f32_16x16x32_bf16 v[212:215], v[176:179], a[252:255], v[212:215]
  v_and_or_b32 v62, v62, v49, s58
  v_and_or_b32 v66, v66, v49, s58
  s_nop 5
  v_cvt_pk_bf16_f32 v55, v208, v212
  v_and_or_b32 v55, v55, v49, s59
  buffer_store_dwordx4 v[52:55], v37, s[28:31], s6 offen offset:0 sc1
  v_cvt_pk_bf16_f32 v59, v209, v213
  v_and_or_b32 v59, v59, v49, s59
  buffer_store_dwordx4 v[56:59], v37, s[28:31], s6 offen offset:1024 sc1
  v_cvt_pk_bf16_f32 v63, v210, v214
  v_and_or_b32 v63, v63, v49, s59
  buffer_store_dwordx4 v[60:63], v37, s[28:31], s6 offen offset:2048 sc1
  v_cvt_pk_bf16_f32 v67, v211, v215
  v_and_or_b32 v67, v67, v49, s59
  buffer_store_dwordx4 v[64:67], v37, s[28:31], s6 offen offset:3072 sc1
  s_cmp_gt_u32 s72, 108
  s_cbranch_scc1 L_a_done
  v_lshrrev_b32 v10, 1, v2
  v_and_b32 v11, 19, v10
  v_bfe_u32 v12, v10, 2, 1
  v_lshl_or_b32 v11, v12, 3, v11
  v_bfe_u32 v12, v10, 3, 1
  v_lshl_or_b32 v11, v12, 2, v11
  v_mul_u32_u24 v11, 3456, v11
  v_and_b32 v12, 1, v2
  v_lshl_add_u32 v16, v12, 4, v11
  s_mul_i32 s60, s54, 110592
  s_lshl_b32 s61, s72, 5
  s_add_u32 s60, s60, s61
  s_lshl_b32 s71, s54, 10
  s_mul_i32 s61, s72, 20480
  s_add_u32 s61, s61, s71
  s_and_b32 s62, s53, 3
  s_barrier
  s_lshl_b32 s4, s62, 12
  s_add_u32 m0, s4, s71
  s_mul_i32 s4, s62, 442368
  s_add_u32 s4, s4, s60
  buffer_load_dwordx4 v16, s[36:39], s4 offen lds
  s_add_u32 s62, s62, 1
  s_cmp_eq_u32 s62, 5
  s_cselect_b32 s62, 0, s62
  s_add_u32 m0, s71, 20480
  s_nop 0
  buffer_load_dwordx4 v37, s[40:43], s61 offen lds
  s_add_u32 m0, s71, 24576
  s_add_u32 s61, s61, 4096
  buffer_load_dwordx4 v37, s[40:43], s61 offen lds
  s_add_u32 m0, s71, 28672
  s_add_u32 s61, s61, 4096
  buffer_load_dwordx4 v37, s[40:43], s61 offen lds
  s_add_u32 m0, s71, 32768
  s_add_u32 s61, s61, 4096
  buffer_load_dwordx4 v37, s[40:43], s61 offen lds
  s_add_u32 m0, s71, 36864
  s_add_u32 s61, s61, 4096
  buffer_load_dwordx4 v37, s[40:43], s61 offen lds
  s_lshl_b32 s4, s62, 12
  s_add_u32 m0, s4, s71
  s_mul_i32 s4, s62, 442368
  s_add_u32 s4, s4, s60
  buffer_load_dwordx4 v16, s[36:39], s4 offen lds
  s_add_u32 s62, s62, 1
  s_cmp_eq_u32 s62, 5
  s_cselect_b32 s62, 0, s62
  s_lshl_b32 s4, s62, 12
  s_add_u32 m0, s4, s71
  s_mul_i32 s4, s62, 442368
  s_add_u32 s4, s4, s60
  buffer_load_dwordx4 v16, s[36:39], s4 offen lds
  s_add_u32 s62, s62, 1
  s_cmp_eq_u32 s62, 5
  s_cselect_b32 s62, 0, s62
  s_lshl_b32 s4, s62, 12
  s_add_u32 m0, s4, s71
  s_mul_i32 s4, s62, 442368
  s_add_u32 s4, s4, s60
  buffer_load_dwordx4 v16, s[36:39], s4 offen lds
  s_add_u32 s62, s62, 1
  s_cmp_eq_u32 s62, 5
  s_cselect_b32 s62, 0, s62
  s_lshl_b32 s4, s62, 12
  s_add_u32 m0, s4, s71
  s_mul_i32 s4, s62, 442368
  s_add_u32 s4, s4, s60
  buffer_load_dwordx4 v16, s[36:39], s4 offen lds
  s_add_u32 s62, s62, 1
  s_cmp_eq_u32 s62, 5
  s_cselect_b32 s62, 0, s62
  v_bfe_u32 v10, v3, 2, 1
  v_lshlrev_b32 v10, 4, v10
  v_mov_b32 v11, 0x3f80
  v_lshlrev_b32 v10, v10, v11
  v_and_b32 v11, 11, v3
  v_cmp_eq_u32 vcc, 0, v11
  s_nop 1
  v_cndmask_b32 v224, 0, v10, vcc
  v_cmp_eq_u32 vcc, 1, v11
  s_nop 1
  v_cndmask_b32 v225, 0, v10, vcc
  v_cmp_eq_u32 vcc, 2, v11
  s_nop 1
  v_cndmask_b32 v226, 0, v10, vcc
  v_cmp_eq_u32 vcc, 3, v11
  s_nop 1
  v_cndmask_b32 v227, 0, v10, vcc
  v_cmp_eq_u32 vcc, 8, v11
  s_nop 1
  v_cndmask_b32 v228, 0, v10, vcc
  v_cmp_eq_u32 vcc, 9, v11
  s_nop 1
  v_cndmask_b32 v229, 0, v10, vcc
  v_cmp_eq_u32 vcc, 10, v11
  s_nop 1
  v_cndmask_b32 v230, 0, v10, vcc
  v_cmp_eq_u32 vcc, 11, v11
  s_nop 1
  v_cndmask_b32 v231, 0, v10, vcc
  v_and_b32 v10, 1, v4
  v_lshlrev_b32 v10, 7, v10
  v_lshrrev_b32 v11, 1, v4
  v_lshl_or_b32 v10, v11, 9, v10
  v_lshl_or_b32 v17, v3, 3, v10
  s_cmp_eq_u32 s54, 3
  s_cselect_b32 s60, 32, 96
  s_cselect_b32 s62, 4, 12
  s_mul_i32 s61, s54, 384
  v_lshrrev_b32 v10, 2, v2
  v_mul_u32_u24 v10, 1280, v10
  v_and_b32 v11, 3, v3
  v_mul_u32_u24 v11, s60, v11
  v_add3_u32 v18, v10, v11, s61
  v_mul_u32_u24 v11, s60, v4
  v_add_lshl_u32 v11, v11, s61, 1
  v_lshl_add_u32 v11, v3, 4, v11
  v_mov_b32 v28, v11
  v_cmp_le_u32 vcc, 1280, v11
  v_add_u32 v10, 6912, v11
  s_nop 0
  v_cndmask_b32 v11, v11, v10, vcc
  v_xor_b32 v11, s3, v11
  s_and_b32 s61, s72, 0x7c
  s_add_u32 s61, s61, s72
  s_lshl_b32 s61, s61, 11
  s_add_u32 s61, s61, 524288
  v_add_u32 v24, s61, v11
  v_cmp_gt_u32 s[16:17], s62, v3
  v_and_b32 v10, 2, v4
  v_add_lshl_u32 v10, v10, v4, 12
  v_lshl_add_u32 v10, v3, 4, v10
  s_lshl_b32 s61, s54, 8
  s_add_u32 s61, s61, 1048576
  s_and_b32 s63, s52, 3
  s_lshl_b32 s63, s63, 16
  s_add_u32 s63, s63, s19
  s_add_u32 s61, s61, s63
  v_add_u32 v19, s61, v10
  v_and_b32 v10, 1, v4
  v_mul_u32_u24 v11, 1312, v10
  v_lshrrev_b32 v12, 1, v4
  v_lshl_add_u32 v11, v12, 9, v11
  v_lshl_add_u32 v11, v3, 3, v11
  s_lshl_b32 s61, s54, 7
  s_add_u32 s61, s61, 40960
  v_add_u32 v20, s61, v11
  v_lshlrev_b32 v10, 6, v10
  v_lshl_or_b32 v10, v12, 3, v10
  s_lshl_b32 s61, s54, 4
  s_add_u32 s61, s61, 43584
  v_add_u32 v22, s61, v10
  v_and_b32 v10, 1, v3
  v_mul_u32_u24 v11, 1312, v10
  v_lshl_add_u32 v11, v4, 4, v11
  v_add_u32 v21, 40960, v11
  v_lshlrev_b32 v10, 6, v10
  v_add_u32 v23, 43584, v10
  v_lshrrev_b32 v10, 1, v3
  v_cmp_eq_u32 s[4:5], 0, v10
  v_cmp_eq_u32 s[6:7], 1, v10
  v_cmp_eq_u32 s[8:9], 2, v10
  v_cmp_eq_u32 s[10:11], 3, v10
  v_cmp_eq_u32 s[12:13], 4, v10
  v_cmp_eq_u32 s[14:15], 5, v10
  v_and_b32 v11, 7, v2
  s_lshl_b32 s60, s52, 10
  s_add_u32 s60, s60, 16384
  s_add_u32 s60, s60, s19
  v_lshl_add_u32 v25, v11, 7, s60
  s_lshl_b32 s60, s52, 7
  s_add_u32 s60, s60, 32768
  v_lshl_add_u32 v26, v3, 10, s60
  s_lshl_b32 s18, s53, 2
  s_add_u32 s18, s18, s54
  s_mov_b32 s65, 32768
  v_mov_b32 v152, 0
  v_mov_b32 v153, 0
  v_mov_b32 v154, 0
  v_mov_b32 v155, 0
  s_cmp_lg_u32 s54, 3
  s_cbranch_scc1 L_nowarmAF
  s_mov_b64 exec, 0
  s_branch L_hop_AF_0
L_hop_AF_ret:
  s_mov_b64 exec, -1
L_nowarmAF:
L_hop_AF_0:
  s_cbranch_execz L_hop_AF_1
  s_waitcnt vmcnt(4)
  s_barrier
  ds_read_b64_tr_b16 a[80:81], v18 offset:20480
  ds_read_b64_tr_b16 a[82:83], v18 offset:20488
  ds_read_b64_tr_b16 a[84:85], v18 offset:20496
  ds_read_b64_tr_b16 a[86:87], v18 offset:20504
  ds_read_b64_tr_b16 a[88:89], v18 offset:20512
  ds_read_b64_tr_b16 a[90:91], v18 offset:20520
  ds_read_b64_tr_b16 a[92:93], v18 offset:20528
  ds_read_b64_tr_b16 a[94:95], v18 offset:20536
  ds_read_b64_tr_b16 a[96:97], v18 offset:20544
  ds_read_b64_tr_b16 a[98:99], v18 offset:20552
  ds_read_b64_tr_b16 a[100:101], v18 offset:20560
  ds_read_b64_tr_b16 a[102:103], v18 offset:20568
  s_waitcnt vmcnt(0)
  s_barrier
  v_not_b32 v13, s55
  s_cmp_lg_u32 s54, 0
  s_cbranch_scc1 L_a_f3_s
  buffer_load_dword v13, v25, s[28:31], 0 offen sc1
L_a_f3_s:
  ds_read_b64_tr_b16 a[0:1], v17 offset:0
  ds_read_b64_tr_b16 a[2:3], v17 offset:256
  ds_read_b64_tr_b16 a[4:5], v17 offset:1024
  ds_read_b64_tr_b16 a[6:7], v17 offset:1280
  ds_read_b64_tr_b16 a[8:9], v17 offset:2048
  ds_read_b64_tr_b16 a[10:11], v17 offset:2304
  ds_read_b64_tr_b16 a[12:13], v17 offset:3072
  ds_read_b64_tr_b16 a[14:15], v17 offset:3328
  ds_read_b64_tr_b16 a[16:17], v17 offset:4096
  ds_read_b64_tr_b16 a[18:19], v17 offset:4352
  ds_read_b64_tr_b16 a[20:21], v17 offset:5120
  ds_read_b64_tr_b16 a[22:23], v17 offset:5376
  s_waitcnt lgkmcnt(10)
  v_mfma_f32_16x16x32_bf16 v[180:183], a[0:3], v[44:47], 0
  ds_read_b64_tr_b16 a[24:25], v17 offset:6144
  ds_read_b64_tr_b16 a[26:27], v17 offset:6400
  s_waitcnt lgkmcnt(10)
  v_mfma_f32_16x16x32_bf16 v[180:183], a[4:7], v[44:47], v[180:183]
  ds_read_b64_tr_b16 a[28:29], v17 offset:7168
  ds_read_b64_tr_b16 a[30:31], v17 offset:7424
  s_waitcnt lgkmcnt(10)
  v_mfma_f32_16x16x32_bf16 v[180:183], a[8:11], v[44:47], v[180:183]
  ds_read_b64_tr_b16 a[32:33], v17 offset:8192
  ds_read_b64_tr_b16 a[34:35], v17 offset:8448
  s_waitcnt lgkmcnt(10)
  v_mfma_f32_16x16x32_bf16 v[180:183], a[12:15], v[44:47], v[180:183]
  ds_read_b64_tr_b16 a[36:37], v17 offset:9216
  ds_read_b64_tr_b16 a[38:39], v17 offset:9472
  s_waitcnt lgkmcnt(10)
  v_mfma_f32_16x16x32_bf16 v[180:183], a[16:19], v[44:47], v[180:183]
  ds_read_b64_tr_b16 a[40:41], v17 offset:10240
  ds_read_b64_tr_b16 a[42:43], v17 offset:10496
  s_waitcnt lgkmcnt(10)
  v_mfma_f32_16x16x32_bf16 v[180:183], a[20:23], v[44:47], v[180:183]
  ds_read_b64_tr_b16 a[44:45], v17 offset:11264
  ds_read_b64_tr_b16 a[46:47], v17 offset:11520
  s_waitcnt lgkmcnt(10)
  v_mfma_f32_16x16x32_bf16 v[180:183], a[24:27], v[44:47], v[180:183]
  ds_read_b64_tr_b16 a[48:49], v17 offset:12288
  ds_read_b64_tr_b16 a[50:51], v17 offset:12544
  s_waitcnt lgkmcnt(10)
  v_mfma_f32_16x16x32_bf16 v[180:183], a[28:31], v[44:47], v[180:183]
  ds_read_b64_tr_b16 a[52:53], v17 offset:13312
  ds_read_b64_tr_b16 a[54:55], v17 offset:13568
  s_waitcnt lgkmcnt(10)
  v_mfma_f32_16x16x32_bf16 v[180:183], a[32:35], v[44:47], v[180:183]
  ds_read_b64_tr_b16 a[56:57], v17 offset:14336
  ds_read_b64_tr_b16 a[58:59], v17 offset:14592
  s_waitcnt lgkmcnt(10)
  v_mfma_f32_16x16x32_bf16 v[180:183], a[36:39], v[44:47], v[180:183]
  ds_read_b64_tr_b16 a[60:61], v17 offset:15360
  ds_read_b64_tr_b16 a[62:63], v17 offset:15616
  s_waitcnt lgkmcnt(10)
  v_mfma_f32_16x16x32_bf16 v[180:183], a[40:43], v[44:47], v[180:183]
  ds_read_b64_tr_b16 a[64:65], v17 offset:16384
  ds_read_b64_tr_b16 a[66:67], v17 offset:16640
  s_waitcnt lgkmcnt(10)
  v_mfma_f32_16x16x32_bf16 v[180:183], a[44:47], v[44:47], v[180:183]
  ds_read_b64_tr_b16 a[68:69], v17 offset:17408
  ds_read_b64_tr_b16 a[70:71], v17 offset:17664
  s_waitcnt lgkmcnt(10)
  v_mfma_f32_16x16x32_bf16 v[180:183], a[48:51], v[44:47], v[180:183]
  ds_read_b64_tr_b16 a[72:73], v17 offset:18432
  ds_read_b64_tr_b16 a[74:75], v17 offset:18688
  s_waitcnt lgkmcnt(10)
  v_mfma_f32_16x16x32_bf16 v[180:183], a[52:55], v[44:47], v[180:183]
  ds_read_b64_tr_b16 a[76:77], v17 offset:19456
  ds_read_b64_tr_b16 a[78:79], v17 offset:19712
  s_waitcnt lgkmcnt(10)
  v_mfma_f32_16x16x32_bf16 v[180:183], a[56:59], v[44:47], v[180:183]
  s_waitcnt lgkmcnt(0)
  v_mfma_f32_16x16x32_bf16 v[180:183], a[60:63], v[44:47], v[180:183]
  v_mfma_f32_16x16x32_bf16 v[180:183], a[64:67], v[44:47], v[180:183]
  v_mfma_f32_16x16x32_bf16 v[180:183], a[68:71], v[44:47], v[180:183]
  v_mfma_f32_16x16x32_bf16 v[180:183], a[72:75], v[44:47], v[180:183]
  v_mfma_f32_16x16x32_bf16 v[180:183], a[76:79], v[44:47], v[180:183]
  s_cmp_lg_u32 s54, 0
  s_cbranch_scc1 L_a_f3
  s_mov_b64 vcc, 0xff
  s_mov_b32 s64, 200000
L_poll7:
  s_mov_b64 exec, vcc
  buffer_load_dword v13, v25, s[28:31], 0 offen sc1
  s_sub_u32 s64, s64, 1
  s_cbranch_scc1 L_end
  s_waitcnt vmcnt(0)
  v_cmp_ne_u32 vcc, s55, v13
  s_cbranch_vccnz L_poll7
  s_mov_b64 exec, -1
  s_sleep 8
L_a_f3:
  s_barrier
  s_cmp_lt_u32 s54, 2
  s_cbranch_scc1 L_e3_six
  s_mov_b32 s64, 200000
L_poll8:
  buffer_load_dwordx4 v[52:55], v19, s[28:31], 0 offen offset:0 sc1
  buffer_load_dwordx4 v[56:59], v19, s[28:31], s65 offen offset:0 sc1
  buffer_load_dwordx4 v[60:63], v19, s[28:31], 0 offen offset:1024 sc1
  buffer_load_dwordx4 v[64:67], v19, s[28:31], s65 offen offset:1024 sc1
  s_sub_u32 s64, s64, 1
  s_cbranch_scc1 L_end
  s_waitcnt vmcnt(3)
  v_xor_b32 v52, s56, v52
  v_xor_b32 v53, s57, v53
  v_xor_b32 v54, s58, v54
  v_xor_b32 v55, s59, v55
  v_or3_b32 v80, v52, v53, v54
  v_or_b32 v80, v80, v55
  v_mfma_f32_16x16x32_bf16 v[148:151], v[224:227], v[52:55], 0
  s_waitcnt vmcnt(2)
  v_xor_b32 v56, s56, v56
  v_xor_b32 v57, s57, v57
  v_xor_b32 v58, s58, v58
  v_xor_b32 v59, s59, v59
  v_or3_b32 v80, v56, v57, v80
  v_or3_b32 v80, v58, v59, v80
  v_mfma_f32_16x16x32_bf16 v[148:151], v[224:227], v[56:59], v[148:151]
  s_waitcnt vmcnt(1)
  v_xor_b32 v60, s56, v60
L_hop_AF_1:
  s_cbranch_execz L_hop_AF_2
  v_xor_b32 v61, s57, v61
  v_xor_b32 v62, s58, v62
  v_xor_b32 v63, s59, v63
  v_or3_b32 v80, v60, v61, v80
  v_or3_b32 v80, v62, v63, v80
  v_mfma_f32_16x16x32_bf16 v[148:151], v[228:231], v[60:63], v[148:151]
  s_waitcnt vmcnt(0)
  v_xor_b32 v64, s56, v64
  v_xor_b32 v65, s57, v65
  v_xor_b32 v66, s58, v66
  v_xor_b32 v67, s59, v67
  v_or3_b32 v80, v64, v65, v80
  v_or3_b32 v80, v66, v67, v80
  v_mfma_f32_16x16x32_bf16 v[148:151], v[228:231], v[64:67], v[148:151]
  v_and_b32 v80, 0x10001, v80
  v_cmp_ne_u32 vcc, 0, v80
  s_cbranch_vccnz L_poll8
  s_branch L_e3_done
L_e3_six:
  s_mov_b32 s64, 200000
L_poll9:
  buffer_load_dwordx4 v[68:71], v19, s[28:31], 0 offen offset:2048 sc1
  buffer_load_dwordx4 v[72:75], v19, s[28:31], s65 offen offset:2048 sc1
  buffer_load_dwordx4 v[52:55], v19, s[28:31], 0 offen offset:0 sc1
  buffer_load_dwordx4 v[56:59], v19, s[28:31], s65 offen offset:0 sc1
  buffer_load_dwordx4 v[60:63], v19, s[28:31], 0 offen offset:1024 sc1
  buffer_load_dwordx4 v[64:67], v19, s[28:31], s65 offen offset:1024 sc1
  s_sub_u32 s64, s64, 1
  s_cbranch_scc1 L_end
  s_waitcnt vmcnt(5)
  v_xor_b32 v68, s56, v68
  v_xor_b32 v69, s57, v69
  v_xor_b32 v70, s58, v70
  v_xor_b32 v71, s59, v71
  v_or3_b32 v80, v68, v69, v70
  v_or_b32 v80, v80, v71
  v_mfma_f32_16x16x32_bf16 v[152:155], v[224:227], v[68:71], 0
  s_waitcnt vmcnt(4)
  v_xor_b32 v72, s56, v72
  v_xor_b32 v73, s57, v73
  v_xor_b32 v74, s58, v74
  v_xor_b32 v75, s59, v75
  v_or3_b32 v80, v72, v73, v80
  v_or3_b32 v80, v74, v75, v80
  v_mfma_f32_16x16x32_bf16 v[152:155], v[224:227], v[72:75], v[152:155]
  s_waitcnt vmcnt(3)
  v_xor_b32 v52, s56, v52
  v_xor_b32 v53, s57, v53
  v_xor_b32 v54, s58, v54
  v_xor_b32 v55, s59, v55
  v_or3_b32 v80, v52, v53, v80
  v_or3_b32 v80, v54, v55, v80
  v_mfma_f32_16x16x32_bf16 v[148:151], v[224:227], v[52:55], 0
  s_waitcnt vmcnt(2)
  v_xor_b32 v56, s56, v56
  v_xor_b32 v57, s57, v57
  v_xor_b32 v58, s58, v58
  v_xor_b32 v59, s59, v59
  v_or3_b32 v80, v56, v57, v80
  v_or3_b32 v80, v58, v59, v80
  v_mfma_f32_16x16x32_bf16 v[148:151], v[224:227], v[56:59], v[148:151]
  v_cvt_pk_bf16_f32 v166, v152, v153
  v_cvt_pk_bf16_f32 v167, v154, v155
  s_bfm_b64 exec, 32, 0
  ds_write_b64 v20, v[166:167] offset:1024
  s_mov_b64 exec, -1
  s_waitcnt vmcnt(1)
  v_xor_b32 v60, s56, v60
  v_xor_b32 v61, s57, v61
  v_xor_b32 v62, s58, v62
  v_xor_b32 v63, s59, v63
  v_or3_b32 v80, v60, v61, v80
  v_or3_b32 v80, v62, v63, v80
  v_mfma_f32_16x16x32_bf16 v[148:151], v[228:231], v[60:63], v[148:151]
  s_waitcnt vmcnt(0)
  v_xor_b32 v64, s56, v64
  v_xor_b32 v65, s57, v65
  v_xor_b32 v66, s58, v66
  v_xor_b32 v67, s59, v67
  v_or3_b32 v80, v64, v65, v80
  v_or3_b32 v80, v66, v67, v80
  v_mfma_f32_16x16x32_bf16 v[148:151], v[228:231], v[64:67], v[148:151]
  v_and_b32 v80, 0x10001, v80
  v_cmp_ne_u32 vcc, 0, v80
  s_cbranch_vccnz L_poll9
L_e3_done:
  v_add_f32 v168, v152, v153
  v_mul_f32 v169, v152, v152
  v_fmac_f32 v169, v153, v153
  v_add_f32 v168, v168, v154
  v_fmac_f32 v169, v154, v154
  v_add_f32 v168, v168, v155
  v_fmac_f32 v169, v155, v155
  v_cvt_pk_bf16_f32 v164, v148, v149
  v_cvt_pk_bf16_f32 v165, v150, v151
  ds_write_b64 v20, v[164:165]
  v_add_f32 v168, v168, v148
  v_fmac_f32 v169, v148, v148
  v_add_f32 v168, v168, v149
  v_fmac_f32 v169, v149, v149
  v_add_f32 v168, v168, v150
  v_fmac_f32 v169, v150, v150
  v_add_f32 v168, v168, v151
  v_fmac_f32 v169, v151, v151
  s_cmp_eq_u32 s72, 108
  s_waitcnt lgkmcnt(0)
  s_barrier
  s_cbranch_scc1 L_a_h
  ds_read_b128 a[104:107], v21 offset:0
  ds_read_b128 a[108:111], v21 offset:64
  ds_read_b128 a[112:115], v21 offset:128
  ds_read_b128 a[116:119], v21 offset:192
  ds_read_b128 a[120:123], v21 offset:256
  ds_read_b128 a[124:127], v21 offset:320
  ds_read_b128 a[128:131], v21 offset:384
  ds_read_b128 a[132:135], v21 offset:448
  v_add_f32_dpp v168, v168, v168 row_ror:8 row_mask:0xf bank_mask:0xf
  v_add_f32_dpp v169, v169, v169 row_ror:8 row_mask:0xf bank_mask:0xf
L_hop_AF_2:
  s_cbranch_execz L_hop_AF_3
  v_add_f32_dpp v168, v168, v168 row_ror:4 row_mask:0xf bank_mask:0xf
  v_add_f32_dpp v169, v169, v169 row_ror:4 row_mask:0xf bank_mask:0xf
  s_nop 0
  v_add_f32_dpp v168, v168, v168 row_ror:2 row_mask:0xf bank_mask:0xf
  v_add_f32_dpp v169, v169, v169 row_ror:2 row_mask:0xf bank_mask:0xf
  s_nop 0
  v_add_f32_dpp v168, v168, v168 row_ror:1 row_mask:0xf bank_mask:0xf
  v_add_f32_dpp v169, v169, v169 row_ror:1 row_mask:0xf bank_mask:0xf
  ds_write_b64 v22, v[168:169]
  s_waitcnt lgkmcnt(1)
  v_mfma_f32_16x16x32_bf16 v[216:219], a[0:3], a[104:107], 0
  ds_read_b128 a[136:139], v21 offset:512
  ds_read_b128 a[140:143], v21 offset:576
  v_mfma_f32_16x16x32_bf16 v[216:219], a[4:7], a[108:111], v[216:219]
  ds_read_b128 a[144:147], v21 offset:640
  ds_read_b128 a[148:151], v21 offset:704
  v_mfma_f32_16x16x32_bf16 v[216:219], a[8:11], a[112:115], v[216:219]
  ds_read_b128 a[152:155], v21 offset:768
  ds_read_b128 a[156:159], v21 offset:832
  v_mfma_f32_16x16x32_bf16 v[216:219], a[12:15], a[116:119], v[216:219]
  ds_read_b128 a[160:163], v21 offset:896
  ds_read_b128 a[164:167], v21 offset:960
  v_mfma_f32_16x16x32_bf16 v[216:219], a[16:19], a[120:123], v[216:219]
  ds_read_b128 a[168:171], v21 offset:1024
  ds_read_b128 a[172:175], v21 offset:1088
  v_mfma_f32_16x16x32_bf16 v[216:219], a[20:23], a[124:127], v[216:219]
  ds_read_b128 a[176:179], v21 offset:1152
  ds_read_b128 a[180:183], v21 offset:1216
  v_mfma_f32_16x16x32_bf16 v[216:219], a[24:27], a[128:131], v[216:219]
  s_waitcnt lgkmcnt(8)
  s_barrier
  v_mfma_f32_16x16x32_bf16 v[216:219], a[28:31], a[132:135], v[216:219]
  ds_read_b128 v[84:87], v23 offset:0
  ds_read_b128 v[88:91], v23 offset:16
  ds_read_b128 v[92:95], v23 offset:32
  ds_read_b128 v[96:99], v23 offset:48
  v_mfma_f32_16x16x32_bf16 v[216:219], a[32:35], a[136:139], v[216:219]
  v_mfma_f32_16x16x32_bf16 v[216:219], a[36:39], a[140:143], v[216:219]
  v_mfma_f32_16x16x32_bf16 v[216:219], a[40:43], a[144:147], v[216:219]
  v_mfma_f32_16x16x32_bf16 v[216:219], a[44:47], a[148:151], v[216:219]
  s_waitcnt lgkmcnt(0)
  v_mfma_f32_16x16x32_bf16 v[216:219], a[48:51], a[152:155], v[216:219]
  v_pk_add_f32 v[84:85], v[84:85], v[92:93]
  v_pk_add_f32 v[86:87], v[86:87], v[94:95]
  v_mfma_f32_16x16x32_bf16 v[216:219], a[52:55], a[156:159], v[216:219]
  v_pk_add_f32 v[88:89], v[88:89], v[96:97]
  v_pk_add_f32 v[90:91], v[90:91], v[98:99]
  v_mfma_f32_16x16x32_bf16 v[216:219], a[56:59], a[160:163], v[216:219]
  v_pk_add_f32 v[84:85], v[84:85], v[88:89]
  v_pk_add_f32 v[86:87], v[86:87], v[90:91]
  v_mfma_f32_16x16x32_bf16 v[216:219], a[60:63], a[164:167], v[216:219]
  v_pk_add_f32 v[84:85], v[84:85], v[86:87]
  v_mul_f32 v84, 0x3acccccd, v84
  v_mfma_f32_16x16x32_bf16 v[216:219], a[64:67], a[168:171], v[216:219]
  v_mul_f32 v85, 0x3acccccd, v85
  v_fma_f32 v85, -v84, v84, v85
  v_mfma_f32_16x16x32_bf16 v[216:219], a[68:71], a[172:175], v[216:219]
  v_max_f32 v85, 0, v85
  v_add_f32 v85, 0x3727c5ac, v85
  v_mfma_f32_16x16x32_bf16 v[216:219], a[72:75], a[176:179], v[216:219]
  v_rsq_f32 v85, v85
  v_mfma_f32_16x16x32_bf16 v[216:219], a[76:79], a[180:183], v[216:219]
  s_cmp_lg_u32 s18, 67
  s_cbranch_scc1 L_a_f4
  s_mov_b64 exec, 0xffff
  buffer_store_dword v50, v26, s[28:31], 0 offen sc1
  s_mov_b64 exec, -1
L_a_f4:
  v_mul_f32 v86, 0xbfb8aa3b, v85
  s_nop 4
  v_fma_f32 v216, -v84, v180, v216
  v_fma_f32 v217, -v84, v181, v217
  v_fma_f32 v218, -v84, v182, v218
  v_fma_f32 v219, -v84, v183, v219
  v_mul_f32 v100, v86, v216
  v_mul_f32 v101, v86, v217
  v_mul_f32 v102, v86, v218
  v_mul_f32 v103, v86, v219
  v_exp_f32 v100, v100
  v_exp_f32 v101, v101
  v_exp_f32 v102, v102
  v_exp_f32 v103, v103
  v_add_f32 v100, 1.0, v100
  v_add_f32 v101, 1.0, v101
  v_add_f32 v102, 1.0, v102
  v_add_f32 v103, 1.0, v103
  v_rcp_f32 v100, v100
  v_mul_f32 v216, v216, v85
  v_rcp_f32 v101, v101
  v_mul_f32 v217, v217, v85
  v_rcp_f32 v102, v102
  v_mul_f32 v218, v218, v85
  v_rcp_f32 v103, v103
  v_mul_f32 v219, v219, v85
  v_mul_f32 v216, v216, v100
  v_mul_f32 v217, v217, v101
  v_mul_f32 v218, v218, v102
  v_mul_f32 v219, v219, v103
  v_cvt_pk_bf16_f32 v10, v216, v217
  v_cvt_pk_bf16_f32 v11, v218, v219
  v_cndmask_b32 v164, 0, v10, s[4:5]
  v_cndmask_b32 v165, 0, v11, s[4:5]
  v_cndmask_b32 v166, 0, v10, s[6:7]
  v_cndmask_b32 v167, 0, v11, s[6:7]
  v_mfma_f32_16x16x16_bf16 v[184:187], a[80:81], v[164:165], 0
  v_mfma_f32_16x16x16_bf16 v[188:191], a[82:83], v[164:165], 0
  v_cndmask_b32 v168, 0, v10, s[8:9]
  v_cndmask_b32 v169, 0, v11, s[8:9]
  v_mfma_f32_16x16x16_bf16 v[184:187], a[84:85], v[166:167], v[184:187]
  v_mfma_f32_16x16x16_bf16 v[188:191], a[86:87], v[166:167], v[188:191]
  v_cndmask_b32 v170, 0, v10, s[10:11]
  v_cndmask_b32 v171, 0, v11, s[10:11]
  v_mfma_f32_16x16x16_bf16 v[184:187], a[88:89], v[168:169], v[184:187]
  v_mfma_f32_16x16x16_bf16 v[188:191], a[90:91], v[168:169], v[188:191]
  v_cndmask_b32 v172, 0, v10, s[12:13]
  v_cndmask_b32 v173, 0, v11, s[12:13]
  v_mfma_f32_16x16x16_bf16 v[184:187], a[92:93], v[170:171], v[184:187]
  v_mfma_f32_16x16x16_bf16 v[188:191], a[94:95], v[170:171], v[188:191]
  v_cndmask_b32 v174, 0, v10, s[14:15]
  v_cndmask_b32 v175, 0, v11, s[14:15]
  v_mfma_f32_16x16x16_bf16 v[184:187], a[96:97], v[172:173], v[184:187]
  v_mfma_f32_16x16x16_bf16 v[188:191], a[98:99], v[172:173], v[188:191]
  v_mfma_f32_16x16x16_bf16 v[184:187], a[100:101], v[174:175], v[184:187]
  v_mfma_f32_16x16x16_bf16 v[188:191], a[102:103], v[174:175], v[188:191]
  s_mov_b64 exec, s[16:17]
L_hop_AF_3:
  s_cbranch_execz L_hop_AF_ret
  s_nop 4
  v_cvt_pk_bf16_f32 v216, v184, v185
  v_and_or_b32 v216, v216, v49, s56
  v_cvt_pk_bf16_f32 v217, v186, v187
  v_and_or_b32 v217, v217, v49, s57
  v_cvt_pk_bf16_f32 v218, v188, v189
  v_and_or_b32 v218, v218, v49, s58
  v_cvt_pk_bf16_f32 v219, v190, v191
  v_and_or_b32 v219, v219, v49, s59
  buffer_store_dwordx4 v[216:219], v24, s[28:31], 0 offen sc1
  s_mov_b64 exec, -1
  s_branch L_a_done
L_a_h:
  v_lshrrev_b32 v11, 5, v28
  v_bfe_u32 v10, v28, 4, 1
  v_mul_u32_u24 v10, 1312, v10
  v_lshl_add_u32 v10, v11, 4, v10
  ds_read_b128 v[216:219], v10 offset:40960
  s_mov_b64 exec, s[16:17]
  s_waitcnt lgkmcnt(0)
  v_and_or_b32 v216, v216, v49, s56
  v_and_or_b32 v217, v217, v49, s57
  v_and_or_b32 v218, v218, v49, s58
  v_and_or_b32 v219, v219, v49, s59
  buffer_store_dwordx4 v[216:219], v24, s[28:31], 0 offen sc1
L_a_done:
L_end:
  s_endpgm
L_codeend:
.section .rodata,"a"
.p2align 6
.amdhsa_kernel sequential_preLN__compressed_kv_cla__dense_activation_silu__decode_kernel
  .amdhsa_next_free_vgpr 488
  .amdhsa_next_free_sgpr 102
  .amdhsa_accum_offset 232
  .amdhsa_group_segment_fixed_size 0
  .amdhsa_kernarg_size 96
  .amdhsa_user_sgpr_count 2
  .amdhsa_user_sgpr_kernarg_segment_ptr 1
  .amdhsa_system_sgpr_workgroup_id_x 1
.end_amdhsa_kernel
```
